```python
import torch

def _softmax(x, axis=-1):
    return torch.softmax(x, dim=axis)
def _gelu(x):
    return torch.nn.functional.gelu(x, approximate="tanh")
def _silu(x):
    return torch.nn.functional.silu(x)
def _sigmoid(x):
    return torch.sigmoid(x)
def _layernorm(x, axis=-1, eps=1e-5):
    m = x.mean(dim=axis, keepdim=True)
    v = x.var(dim=axis, keepdim=True, unbiased=False)
    return (x - m) / torch.sqrt(v + eps)
def _scatter_add(tgt, idx, src, axis=0):
    return tgt.clone().index_add_(axis, idx, src)
def _segment_sum(src, seg, n):
    out = torch.zeros((n,) + src.shape[1:], dtype=src.dtype)
    return out.index_add_(0, seg, src)
def _pad(x, pw):
    flat = tuple(v for pair in reversed(pw) for v in pair)
    return torch.nn.functional.pad(x, flat)

kernel_name = 'standalone__glu_gated_geglu__prompt'

def setup_inputs():

    _w = (lambda a: (lambda t: t.to(torch.bfloat16) if t.is_floating_point() else t)(torch.as_tensor(a)))
    B, S, Dm, Df = 1, 2048, 640, 1728
    return {
        "x": _w((lambda *s: torch.randn(*s, dtype=torch.bfloat16) * 0.05)(B, S, Dm)),
        "w_gate": _w((lambda *s: torch.randn(*s, dtype=torch.bfloat16) * 0.05)(Dm, Df) * (Dm ** -0.5)),
        "w_up": _w((lambda *s: torch.randn(*s, dtype=torch.bfloat16) * 0.05)(Dm, Df) * (Dm ** -0.5)),
        "w_down": _w((lambda *s: torch.randn(*s, dtype=torch.bfloat16) * 0.05)(Df, Dm) * (Df ** -0.5)),
    }

def reference(x, w_gate, w_up, w_down):
    g = torch.einsum("bsd,df->bsf", x, w_gate)
    u = torch.einsum("bsd,df->bsf", x, w_up)
    h = _gelu(g) * u
    return torch.einsum("bsf,fd->bsd", h, w_down)
```

```asm
; @launch grid=(256,1,1) block=(256,1,1) lds=163840
.amdgcn_target "amdgcn-amd-amdhsa--gfx950"
.text
.globl standalone__glu_gated_geglu__prompt_kernel
.p2align 8
.type standalone__glu_gated_geglu__prompt_kernel,@function
standalone__glu_gated_geglu__prompt_kernel:
    s_cmp_ge_u32 s2, 256
    s_cbranch_scc1 L_end
    s_load_dwordx8 s[4:11], s[0:1], 0
    s_load_dwordx4 s[12:15], s[0:1], 32
    s_load_dwordx2 s[16:17], s[0:1], 48
    s_cmp_ge_u32 s2, 40
    s_cbranch_scc1 L_compute
    s_cmp_ge_u32 s2, 8
    s_cbranch_scc1 L_early
    s_getpc_b64 s[80:81]
L_pc:
    s_sub_u32 s80, s80, L_pc-standalone__glu_gated_geglu__prompt_kernel
    s_subb_u32 s81, s81, 0
    v_lshlrev_b32 v1, 7, v0
    v_min_u32 v1, L_codeend-standalone__glu_gated_geglu__prompt_kernel-4, v1
    global_load_dword v8, v1, s[80:81]
    s_branch L_helper
L_early:
    v_readfirstlane_b32 s58, v0
    v_and_b32 v1, 63, v0
    s_sub_u32 s59, s2, 8
    s_mov_b32 s23, 0x20000
    s_lshl_b32 s60, s59, 13
    s_add_u32 s60, s60, 442368
    s_mul_i32 s59, s59, 81920
    s_lshl_b32 s52, s58, 1
    s_add_u32 s59, s59, s52
    s_movk_i32 s52, 128
    s_mov_b32 s22, 663552
    s_cmp_eq_u32 s58, 128
    s_waitcnt lgkmcnt(0)
    s_cselect_b32 s20, s6, s8
    s_cselect_b32 s21, s7, s9
    s_cmp_lt_u32 s58, 128
    s_cselect_b32 s20, s4, s20
    s_cselect_b32 s21, s5, s21
    s_cselect_b32 s22, 2621440, s22
    s_cselect_b32 s59, s59, s60
    s_cselect_b32 s52, 1280, s52
    v_mul_u32_u24 v1, s52, v1
    buffer_load_dword v8, v1, s[20:23], s59 offen
    s_branch L_helper
L_compute:
    v_lshrrev_b32 v1, 6, v0
    v_and_b32 v0, 63, v0
    s_and_b32 s62, s2, 7
    s_lshr_b32 s63, s2, 3
    v_readfirstlane_b32 s48, v1
    s_lshr_b32 s71, s62, 1
    s_mul_i32 s60, s71, 27
    s_add_u32 s60, s60, s63
    s_sub_u32 s60, s60, 5
    s_lshr_b32 s49, s60, 2
    s_and_b32 s60, s60, 3
    s_and_b32 s58, s62, 1
    s_lshl_b32 s58, s58, 2
    s_add_u32 s50, s60, s58
    v_lshrrev_b32 v2, 3, v0
    v_and_b32 v3, 7, v0
    v_lshrrev_b32 v4, 4, v0
    s_and_b32 s58, s48, 1
    s_mul_i32 s58, s58, 110592
    v_and_b32 v5, 1, v4
    v_lshlrev_b32 v5, 1, v5
    v_xor_b32 v5, v5, v3
    v_mul_u32_u24 v6, 3456, v2
    v_add_u32 v6, s58, v6
    v_lshl_add_u32 v248, v5, 4, v6
    v_xor_b32 v5, 4, v5
    v_lshl_add_u32 v6, v5, 4, v6
    v_add_u32 v249, 26624, v6
    v_add_u32 v250, 53248, v248
    v_add_u32 v251, 79872, v6
    s_lshl_b32 s58, s50, 2
    s_add_u32 s58, s58, s48
    s_mul_i32 s58, s58, 81920
    v_mul_u32_u24 v5, 1280, v2
    v_add_u32 v5, s58, v5
    v_xor_b32 v6, v3, v4
    v_lshl_add_u32 v240, v6, 4, v5
    v_xor_b32 v6, 4, v6
    v_lshl_add_u32 v6, v6, 4, v5
    v_add_u32 v241, 9216, v6
    v_add_u32 v242, 18432, v240
    v_add_u32 v243, 27648, v6
    v_add_u32 v244, 40960, v240
    v_add_u32 v245, 50176, v6
    v_add_u32 v246, 59392, v240
    v_add_u32 v247, 68608, v6
    s_mov_b32 s22, 2621440
    s_mov_b32 s23, 0x20000
    s_mov_b32 s26, 2211840
    s_mov_b32 s27, 0x20000
    s_lshl_b32 s70, s49, 7
    s_and_b32 s58, s50, 0
    s_add_u32 s71, s71, s58
    s_lshl_b32 s58, s62, 0
    s_add_u32 s71, s71, s58
    s_and_b32 s71, s71, 1
    s_lshl_b32 s54, s71, 7
    s_mul_i32 s55, s71, 221184
    s_add_u32 s55, s55, s70
    s_lshl_b32 s56, s48, 13
    s_lshl_b32 s57, s48, 12
    s_add_u32 s57, s57, 32768
    s_cmp_lt_u32 s48, 2
    s_waitcnt lgkmcnt(0)
    s_mov_b32 s20, s4
    s_mov_b32 s21, s5
    s_cselect_b32 s24, s6, s8
    s_cselect_b32 s25, s7, s9
    s_add_u32 m0, s57, 0
    s_nop 0
    buffer_load_dwordx4 v248, s[24:27], s55 offen offset:0  lds
    buffer_load_dwordx4 v249, s[24:27], s55 offen offset:1024  lds
    buffer_load_dwordx4 v250, s[24:27], s55 offen offset:2048  lds
    buffer_load_dwordx4 v251, s[24:27], s55 offen offset:3072  lds
    s_add_u32 m0, s56, 0
    s_nop 0
    buffer_load_dwordx4 v240, s[20:23], s54 offen offset:0  lds
    buffer_load_dwordx4 v241, s[20:23], s54 offen offset:1024  lds
    buffer_load_dwordx4 v242, s[20:23], s54 offen offset:2048  lds
    buffer_load_dwordx4 v243, s[20:23], s54 offen offset:3072  lds
    v_and_b32 v5, 15, v0
    v_lshrrev_b32 v7, 1, v5
    v_xor_b32 v7, v7, v4
    v_lshlrev_b32 v5, 7, v5
    s_lshr_b32 s59, s48, 1
    s_lshl_b32 s58, s59, 14
    v_add_u32 v5, s58, v5
    v_lshl_add_u32 v9, v7, 4, v5
    v_xor_b32 v7, 4, v7
    v_lshl_add_u32 v10, v7, 4, v5
    v_mov_b32 v252, v9
    v_mov_b32 v253, v10
    v_bfe_u32 v7, v0, 2, 2
    v_lshl_add_u32 v8, v4, 3, v7
    v_lshlrev_b32 v8, 7, v8
    v_and_b32 v6, 3, v0
    v_lshl_add_u32 v8, v6, 3, v8
    v_add_u32 v8, 32768, v8
    v_lshrrev_b32 v7, 1, v7
    v_and_b32 v6, 1, v4
    v_lshl_or_b32 v7, v6, 1, v7
    s_and_b32 s60, s48, 1
    s_lshl_b32 s58, s60, 1
    v_xor_b32 v7, s58, v7
    v_lshl_add_u32 v11, v7, 5, v8
    v_xor_b32 v7, 1, v7
    v_lshl_add_u32 v12, v7, 5, v8
    v_mov_b32 v254, v11
    v_mov_b32 v255, v12
    s_lshr_b32 s59, s48, 1
    s_and_b32 s60, s48, 1
    s_lshl_b32 s58, s49, 1
    s_add_u32 s60, s58, s60
    s_lshl_b32 s58, s60, 10
    v_lshl_add_u32 v13, v0, 4, s58
    s_lshl_b32 s58, s50, 1
    s_add_u32 s58, s58, s59
    s_mul_i32 s61, s58, 442368
    s_mul_i32 s59, s60, 74
    s_lshr_b32 s59, s59, 10
    s_lshl_b32 s58, s58, 2
    s_add_u32 s58, s58, s59
    s_lshl_b32 s58, s58, 5
    s_mul_i32 s59, s59, 14
    s_sub_u32 s59, s60, s59
    s_add_u32 s58, s58, s59
    s_lshl_b32 s58, s58, 2
    v_lshl_add_u32 v8, v0, 20, s58
    v_mov_b32 v7, 1
    s_mov_b32 s18, 0xc0135761
    s_mov_b32 s19, 0xc0135761
    s_sub_u32 s60, s63, 5
    s_mul_i32 s59, s60, 52
    s_lshr_b32 s59, s59, 8
    s_mul_i32 s58, s59, 5
    s_sub_u32 s60, s60, s58
    s_and_b32 s58, s62, 3
    s_lshl_b32 s58, s58, 1
    s_add_u32 s58, s58, s60
    s_sub_u32 s64, s58, 5
    s_cselect_b32 s58, s58, s64
    s_cmp_ge_u32 s63, 30
    s_cselect_b32 s59, s58, s59
    s_cselect_b32 s60, 5, s60
    s_and_b32 s58, s62, 3
    s_mul_i32 s64, s58, 31
    s_mul_i32 s65, s59, 5
    s_add_u32 s58, s58, s65
    s_lshl_b32 s58, s58, 1
    s_mov_b32 s84, 621367956
    s_mov_b32 s85, 164008
    s_lshr_b64 s[84:85], s[84:85], s58
    s_and_b32 s84, s84, 3
    s_lshl_b32 s84, s84, 1
    s_add_u32 s64, s64, s84
    s_lshr_b32 s65, s62, 2
    s_mul_i32 s65, s65, 5
    s_add_u32 s65, s65, s59
    s_and_b32 s58, s62, 3
    s_lshl_b32 s86, s59, 2
    s_add_u32 s58, s58, s86
    s_lshl_b32 s58, s58, 1
    s_mov_b32 s86, 80528179
    s_mov_b32 s87, 16
    s_lshr_b64 s[86:87], s[86:87], s58
    s_and_b32 s86, s86, 3
    s_sub_u32 s87, 6, s86
    s_sub_u32 s86, 0, s64
    s_and_b32 s86, s86, 3
    s_cmp_ge_u32 s60, s86
    s_cselect_b32 s87, s87, 0
    s_add_u32 s64, s64, s87
    s_mul_i32 s60, s60, 5
    s_add_u32 s64, s64, s60
    s_mov_b32 s34, 2211840
    s_sub_u32 s58, 0, s64
    s_and_b32 s58, s58, 3
    s_add_u32 s58, s64, s58
    s_add_u32 s83, s58, 0
    s_sub_u32 s58, 2, s64
    s_and_b32 s58, s58, 3
    s_add_u32 s58, s64, s58
    s_add_u32 s84, s58, 256
    s_sub_u32 s58, 1, s64
    s_and_b32 s58, s58, 3
    s_add_u32 s58, s64, s58
    s_add_u32 s85, s58, 512
    s_sub_u32 s58, 3, s64
    s_and_b32 s58, s58, 3
    s_add_u32 s58, s64, s58
    s_add_u32 s86, s58, 768
    s_add_u32 s58, s64, 4
    s_and_b32 s59, s58, 1
    s_lshl_b32 s59, s59, 9
    s_and_b32 s60, s58, 2
    s_lshl_b32 s60, s60, 7
    s_add_u32 s58, s58, s59
    s_add_u32 s58, s58, s60
    s_max_u32 s87, s86, s58
    s_min_u32 s58, s86, s58
    s_max_u32 s86, s85, s58
    s_min_u32 s58, s85, s58
    s_max_u32 s85, s84, s58
    s_min_u32 s58, s84, s58
    s_mov_b32 s84, s58
    s_mov_b32 s32, s10
    s_mov_b32 s33, s11
    s_mov_b32 s35, 0x20000
    s_mov_b32 s36, s12
    s_add_u32 m0, s56, 4096
    s_nop 0
    buffer_load_dwordx4 v244, s[20:23], s54 offen offset:0  lds
    s_mov_b32 s37, s13
    s_mov_b32 s38, 2621440
    s_mov_b32 s39, 0x20000
    s_mov_b32 s40, s14
    s_mov_b32 s41, s15
    s_mov_b32 s42, 4
    s_mov_b32 s43, 0x20000
    s_add_u32 s44, s16, 12582912
    s_addc_u32 s45, s17, 0
    s_mov_b32 s46, 40960
    s_mov_b32 s47, 0x20000
    s_mov_b32 s28, s16
    s_mov_b32 s29, s17
    s_mov_b32 s30, 7077888
    s_mov_b32 s31, 0x20000
    s_movk_i32 s81, 8192
    s_movk_i32 s3, 16384
    s_movk_i32 s75, 24576
    s_lshl_b32 s69, s48, 11
    s_mul_i32 s58, s48, 14336
    buffer_load_dwordx4 v245, s[20:23], s54 offen offset:1024  lds
    v_lshl_add_u32 v65, v0, 4, s58
    v_accvgpr_write_b32 a227, v65
    s_cmp_eq_u32 s48, 3
    s_cselect_b32 s58, 2130706432, 0
    v_or_b32 v65, s58, v65
    v_accvgpr_write_b32 a228, v65
    v_lshrrev_b32 v65, 3, v0
    v_and_b32 v66, 7, v0
    v_mul_u32_u24 v67, 1280, v65
    v_lshl_add_u32 v67, v66, 4, v67
    s_lshl_b32 s59, s65, 7
    s_mul_i32 s58, s48, 573440
    s_add_u32 s58, s58, s59
    v_lshrrev_b32 v68, 4, v0
    v_lshlrev_b32 v68, 5, v68
    v_xor_b32 v68, v68, v67
    v_add_u32 v2, s58, v68
    s_and_b32 s58, s48, 1
    s_mul_i32 s60, s58, 10240
    s_add_u32 s60, s60, s59
    buffer_load_dwordx4 v246, s[20:23], s54 offen offset:2048  lds
    v_add_u32 v67, s60, v67
    v_accvgpr_write_b32 a224, v67
    s_lshl_b32 s58, s58, 3
    v_add_u32 v65, s58, v65
    v_and_b32 v67, 1, v66
    v_mad_u32_u24 v65, v65, 9, v67
    v_and_b32 v65, 15, v65
    v_lshl_add_u32 v65, v67, 5, v65
    v_lshrrev_b32 v66, 1, v66
    v_mul_u32_u24 v66, 66, v66
    v_add_u32 v65, v65, v66
    s_lshr_b32 s58, s48, 1
    s_mul_i32 s58, s58, 16896
    v_lshl_add_u32 v65, v65, 4, s58
    v_accvgpr_write_b32 a225, v65
    v_and_b32 v65, 15, v0
    v_lshrrev_b32 v66, 4, v0
    v_lshrrev_b32 v67, 5, v0
    v_mad_u32_u24 v67, v65, 9, v67
    v_and_b32 v67, 15, v67
    buffer_load_dwordx4 v247, s[20:23], s54 offen offset:3072  lds
    v_lshl_add_u32 v67, v66, 4, v67
    s_mul_i32 s58, s48, 4224
    v_lshl_add_u32 v67, v67, 4, s58
    v_accvgpr_write_b32 a226, v67
    v_lshrrev_b32 v67, 2, v0
    v_lshlrev_b32 v67, 7, v67
    v_and_b32 v68, 3, v0
    v_lshl_add_u32 v67, v68, 3, v67
    v_bfe_u32 v68, v0, 3, 2
    v_lshl_add_u32 v67, v68, 5, v67
    s_add_u32 s58, s69, 49152
    v_add_u32 v3, s58, v67
    s_lshl_b32 s58, s48, 7
    v_lshl_add_u32 v67, v0, 2, s58
    s_cmp_lt_u32 s48, 3
    s_cselect_b32 s72, 14, 12
    v_mov_b32 v64, 2147483392
    v_cmp_gt_u32 vcc, s72, v0
    s_nop 1
    v_cndmask_b32 v5, v64, v67, vcc
    s_waitcnt vmcnt(4)
    s_add_u32 s71, s71, 1
    s_and_b32 s71, s71, 1
    s_lshl_b32 s54, s71, 7
    s_mul_i32 s55, s71, 221184
    s_add_u32 s55, s55, s70
    s_add_u32 m0, s57, 49152
    s_nop 0
    buffer_load_dwordx4 v248, s[24:27], s55 offen offset:0  lds
    buffer_load_dwordx4 v249, s[24:27], s55 offen offset:1024  lds
    buffer_load_dwordx4 v250, s[24:27], s55 offen offset:2048  lds
    buffer_load_dwordx4 v251, s[24:27], s55 offen offset:3072  lds
    s_barrier
    ds_read_b64_tr_b16 v[144:145], v254 offset:0
    ds_read_b64_tr_b16 v[146:147], v254 offset:512
    ds_read_b64_tr_b16 v[192:193], v254 offset:4096
    ds_read_b64_tr_b16 v[194:195], v254 offset:4608
    ds_read_b128 v[160:163], v252 offset:0
    ds_read_b128 v[208:211], v253 offset:0
    ds_read_b64_tr_b16 v[148:149], v255 offset:0
    ds_read_b64_tr_b16 v[150:151], v255 offset:512
    ds_read_b64_tr_b16 v[196:197], v255 offset:4096
    ds_read_b64_tr_b16 v[198:199], v255 offset:4608
    ds_read_b64_tr_b16 v[152:153], v254 offset:8192
    ds_read_b64_tr_b16 v[154:155], v254 offset:8704
    ds_read_b64_tr_b16 v[200:201], v254 offset:12288
    ds_read_b64_tr_b16 v[202:203], v254 offset:12800
    ds_read_b64_tr_b16 v[156:157], v255 offset:8192
    ds_read_b64_tr_b16 v[158:159], v255 offset:8704
    ds_read_b64_tr_b16 v[204:205], v255 offset:12288
    ds_read_b64_tr_b16 v[206:207], v255 offset:12800
    s_add_u32 m0, s56, 49152
    s_nop 0
    buffer_load_dwordx4 v240, s[20:23], s54 offen offset:0  lds
    buffer_load_dwordx4 v241, s[20:23], s54 offen offset:1024  lds
    s_mov_b64 s[10:11], vcc
    s_lshr_b32 s58, s83, 8
    s_lshl_b32 s58, s58, 13
    s_and_b32 s59, s83, 0xf8
    s_lshl_b32 s59, s59, 6
    s_add_u32 s4, s58, s59
    s_and_b32 s83, s83, 0xff
    s_lshr_b32 s58, s84, 8
    s_lshl_b32 s58, s58, 13
    s_and_b32 s59, s84, 0xf8
    s_lshl_b32 s59, s59, 6
    s_add_u32 s5, s58, s59
    s_and_b32 s84, s84, 0xff
    s_lshr_b32 s58, s85, 8
    s_lshl_b32 s58, s58, 13
    s_and_b32 s59, s85, 0xf8
    s_lshl_b32 s59, s59, 6
    s_add_u32 s6, s58, s59
    s_and_b32 s85, s85, 0xff
    s_lshr_b32 s58, s86, 8
    s_lshl_b32 s58, s58, 13
    s_and_b32 s59, s86, 0xf8
    s_lshl_b32 s59, s59, 6
    s_add_u32 s7, s58, s59
    s_waitcnt lgkmcnt(0)
    v_mfma_f32_16x16x32_bf16 v[16:19], v[144:147], v[160:163], 0
    ds_read_b128 v[164:167], v252 offset:2048
    v_mfma_f32_16x16x32_bf16 v[16:19], v[192:195], v[208:211], v[16:19]
    ds_read_b128 v[212:215], v253 offset:2048
    v_mfma_f32_16x16x32_bf16 v[20:23], v[148:151], v[160:163], 0
    buffer_load_dwordx4 v242, s[20:23], s54 offen offset:2048  lds
    v_mfma_f32_16x16x32_bf16 v[20:23], v[196:199], v[208:211], v[20:23]
    ds_read_b128 v[176:179], v252 offset:8192
    v_mfma_f32_16x16x32_bf16 v[24:27], v[152:155], v[160:163], 0
    buffer_load_dwordx4 v243, s[20:23], s54 offen offset:3072  lds
    v_mfma_f32_16x16x32_bf16 v[24:27], v[200:203], v[208:211], v[24:27]
    ds_read_b128 v[224:227], v253 offset:8192
    v_mfma_f32_16x16x32_bf16 v[28:31], v[156:159], v[160:163], 0
    ds_read_b128 v[180:183], v252 offset:10240
    v_mfma_f32_16x16x32_bf16 v[28:31], v[204:207], v[208:211], v[28:31]
    s_add_u32 m0, s56, 53248
    s_nop 0
    buffer_load_dwordx4 v244, s[20:23], s54 offen offset:0  lds
    s_waitcnt lgkmcnt(3)
    v_mfma_f32_16x16x32_bf16 v[32:35], v[144:147], v[164:167], 0
    ds_read_b128 v[228:231], v253 offset:10240
    v_mfma_f32_16x16x32_bf16 v[32:35], v[192:195], v[212:215], v[32:35]
    s_and_b32 s86, s86, 0xff
    s_lshr_b32 s58, s87, 8
    s_lshl_b32 s58, s58, 13
    s_and_b32 s59, s87, 0xf8
    v_mfma_f32_16x16x32_bf16 v[36:39], v[148:151], v[164:167], 0
    buffer_load_dwordx4 v245, s[20:23], s54 offen offset:1024  lds
    v_mfma_f32_16x16x32_bf16 v[36:39], v[196:199], v[212:215], v[36:39]
    s_lshl_b32 s59, s59, 6
    s_add_u32 s8, s58, s59
    s_and_b32 s87, s87, 0xff
    s_cmp_lt_u32 s48, 2
    s_cselect_b32 s76, s83, s84
    v_mfma_f32_16x16x32_bf16 v[40:43], v[152:155], v[164:167], 0
    s_mul_i32 s76, s76, 20480
    s_cmp_lt_u32 s48, 2
    s_cselect_b32 s77, s85, s86
    s_mul_i32 s77, s77, 20480
    v_mfma_f32_16x16x32_bf16 v[40:43], v[200:203], v[212:215], v[40:43]
    buffer_load_dwordx4 v246, s[20:23], s54 offen offset:2048  lds
    v_mfma_f32_16x16x32_bf16 v[44:47], v[156:159], v[164:167], 0
    s_cmp_lt_u32 s48, 2
    s_cselect_b32 s78, s87, s87
    s_mul_i32 s78, s78, 20480
    s_mul_i32 s83, s83, 55296
    v_mfma_f32_16x16x32_bf16 v[44:47], v[204:207], v[212:215], v[44:47]
    s_mul_i32 s84, s84, 55296
    s_mul_i32 s85, s85, 55296
    s_mul_i32 s86, s86, 55296
    s_mul_i32 s87, s87, 55296
    s_waitcnt lgkmcnt(2)
    v_mfma_f32_16x16x32_bf16 v[80:83], v[144:147], v[176:179], 0
    buffer_load_dwordx4 v247, s[20:23], s54 offen offset:3072  lds
    v_mfma_f32_16x16x32_bf16 v[80:83], v[192:195], v[224:227], v[80:83]
    s_sub_u32 s74, s63, 16
    s_or_b32 s74, s74, s48
    v_mfma_f32_16x16x32_bf16 v[84:87], v[148:151], v[176:179], 0
    v_mfma_f32_16x16x32_bf16 v[84:87], v[196:199], v[224:227], v[84:87]
    s_movk_i32 s54, 256
    s_add_u32 s55, s70, 442368
    s_add_u32 m0, s57, 98304
    s_nop 0
    buffer_load_dwordx4 v248, s[24:27], s55 offen offset:0  lds
    v_mfma_f32_16x16x32_bf16 v[88:91], v[152:155], v[176:179], 0
    v_mfma_f32_16x16x32_bf16 v[88:91], v[200:203], v[224:227], v[88:91]
    v_mfma_f32_16x16x32_bf16 v[92:95], v[156:159], v[176:179], 0
    buffer_load_dwordx4 v249, s[24:27], s55 offen offset:1024  lds
    v_mfma_f32_16x16x32_bf16 v[92:95], v[204:207], v[224:227], v[92:95]
    s_waitcnt lgkmcnt(0)
    v_mfma_f32_16x16x32_bf16 v[96:99], v[144:147], v[180:183], 0
    v_mfma_f32_16x16x32_bf16 v[96:99], v[192:195], v[228:231], v[96:99]
    buffer_load_dwordx4 v250, s[24:27], s55 offen offset:2048  lds
    v_mfma_f32_16x16x32_bf16 v[100:103], v[148:151], v[180:183], 0
    v_mfma_f32_16x16x32_bf16 v[100:103], v[196:199], v[228:231], v[100:103]
    v_mfma_f32_16x16x32_bf16 v[104:107], v[152:155], v[180:183], 0
    buffer_load_dwordx4 v251, s[24:27], s55 offen offset:3072  lds
    v_mfma_f32_16x16x32_bf16 v[104:107], v[200:203], v[228:231], v[104:107]
    v_mfma_f32_16x16x32_bf16 v[108:111], v[156:159], v[180:183], 0
    v_mfma_f32_16x16x32_bf16 v[108:111], v[204:207], v[228:231], v[108:111]
    s_waitcnt vmcnt(16)
    s_barrier
    ds_read_b128 v[168:171], v252 offset:4096
    ds_read_b128 v[216:219], v253 offset:4096
    ds_read_b128 v[184:187], v252 offset:12288
    ds_read_b128 v[232:235], v253 offset:12288
    ds_read_b128 v[188:191], v252 offset:14336
    ds_read_b128 v[236:239], v253 offset:14336
    ds_read_b128 v[172:175], v252 offset:6144
    ds_read_b128 v[220:223], v253 offset:6144
    s_waitcnt lgkmcnt(6)
    v_mfma_f32_16x16x32_bf16 v[48:51], v[144:147], v[168:171], 0
    v_mfma_f32_16x16x32_bf16 v[48:51], v[192:195], v[216:219], v[48:51]
    v_mfma_f32_16x16x32_bf16 v[52:55], v[148:151], v[168:171], 0
    s_add_u32 m0, s56, 98304
    s_nop 0
    buffer_load_dwordx4 v240, s[20:23], s54 offen offset:0  lds
    v_mfma_f32_16x16x32_bf16 v[52:55], v[196:199], v[216:219], v[52:55]
    v_mfma_f32_16x16x32_bf16 v[56:59], v[152:155], v[168:171], 0
    v_mfma_f32_16x16x32_bf16 v[56:59], v[200:203], v[216:219], v[56:59]
    buffer_load_dwordx4 v241, s[20:23], s54 offen offset:1024  lds
    v_mfma_f32_16x16x32_bf16 v[60:63], v[156:159], v[168:171], 0
    v_mfma_f32_16x16x32_bf16 v[60:63], v[204:207], v[216:219], v[60:63]
    s_waitcnt lgkmcnt(4)
    v_mfma_f32_16x16x32_bf16 v[112:115], v[144:147], v[184:187], 0
    v_mfma_f32_16x16x32_bf16 v[112:115], v[192:195], v[232:235], v[112:115]
    buffer_load_dwordx4 v242, s[20:23], s54 offen offset:2048  lds
    v_mfma_f32_16x16x32_bf16 v[116:119], v[148:151], v[184:187], 0
    v_mfma_f32_16x16x32_bf16 v[116:119], v[196:199], v[232:235], v[116:119]
    v_mfma_f32_16x16x32_bf16 v[120:123], v[152:155], v[184:187], 0
    buffer_load_dwordx4 v243, s[20:23], s54 offen offset:3072  lds
    v_mfma_f32_16x16x32_bf16 v[120:123], v[200:203], v[232:235], v[120:123]
    v_mfma_f32_16x16x32_bf16 v[124:127], v[156:159], v[184:187], 0
    v_mfma_f32_16x16x32_bf16 v[124:127], v[204:207], v[232:235], v[124:127]
    s_waitcnt lgkmcnt(2)
    v_mfma_f32_16x16x32_bf16 v[128:131], v[144:147], v[188:191], 0
    s_add_u32 m0, s56, 102400
    s_nop 0
    buffer_load_dwordx4 v244, s[20:23], s54 offen offset:0  lds
    v_mfma_f32_16x16x32_bf16 v[128:131], v[192:195], v[236:239], v[128:131]
    v_mfma_f32_16x16x32_bf16 v[132:135], v[148:151], v[188:191], 0
    v_mfma_f32_16x16x32_bf16 v[132:135], v[196:199], v[236:239], v[132:135]
    v_mfma_f32_16x16x32_bf16 v[136:139], v[152:155], v[188:191], 0
    buffer_load_dwordx4 v245, s[20:23], s54 offen offset:1024  lds
    v_mfma_f32_16x16x32_bf16 v[136:139], v[200:203], v[236:239], v[136:139]
    v_mfma_f32_16x16x32_bf16 v[140:143], v[156:159], v[188:191], 0
    v_mfma_f32_16x16x32_bf16 v[140:143], v[204:207], v[236:239], v[140:143]
    buffer_load_dwordx4 v246, s[20:23], s54 offen offset:2048  lds
    s_waitcnt lgkmcnt(0)
    v_mfma_f32_16x16x32_bf16 v[64:67], v[144:147], v[172:175], 0
    v_mfma_f32_16x16x32_bf16 v[64:67], v[192:195], v[220:223], v[64:67]
    v_mfma_f32_16x16x32_bf16 v[68:71], v[148:151], v[172:175], 0
    v_mfma_f32_16x16x32_bf16 v[68:71], v[196:199], v[220:223], v[68:71]
    buffer_load_dwordx4 v247, s[20:23], s54 offen offset:3072  lds
    v_mfma_f32_16x16x32_bf16 v[72:75], v[152:155], v[172:175], 0
    v_mfma_f32_16x16x32_bf16 v[72:75], v[200:203], v[220:223], v[72:75]
    v_mfma_f32_16x16x32_bf16 v[76:79], v[156:159], v[172:175], 0
    v_mfma_f32_16x16x32_bf16 v[76:79], v[204:207], v[220:223], v[76:79]
    v_add_u32 v252, 49152, v9
    v_add_u32 v253, 49152, v10
    v_add_u32 v254, 49152, v11
    v_add_u32 v255, 49152, v12
    s_cmp_eq_u32 s48, 0
    s_cbranch_scc1 L_itk
    s_cmp_eq_u32 s48, 1
    s_cbranch_scc1 L_iti8
    s_cmp_eq_u32 s48, 2
    s_cbranch_scc1 L_itt4
    s_cmp_eq_u32 s48, 3
    s_cbranch_scc1 L_itr1
L_itbk:
L_itbi8:
L_itbt4:
L_itbr1:
    s_branch L_pgk
    .p2align 12
L_itk:
    s_branch L_itbk
L_pgk:
    s_waitcnt vmcnt(12) lgkmcnt(0)
    s_barrier
    s_movk_i32 s54, 384
    s_add_u32 s55, s70, 663552
    s_add_u32 m0, s57, 0
    s_nop 0
    buffer_load_dwordx4 v248, s[24:27], s55 offen offset:0  lds
    buffer_load_dwordx4 v249, s[24:27], s55 offen offset:1024  lds
    buffer_load_dwordx4 v250, s[24:27], s55 offen offset:2048  lds
    buffer_load_dwordx4 v251, s[24:27], s55 offen offset:3072  lds
    s_add_u32 m0, s56, 0
    s_nop 0
    buffer_load_dwordx4 v240, s[20:23], s54 offen offset:0  lds
    buffer_load_dwordx4 v241, s[20:23], s54 offen offset:1024  lds
    ds_read_b64_tr_b16 v[144:145], v254 offset:0
    ds_read_b64_tr_b16 v[146:147], v254 offset:512
    ds_read_b64_tr_b16 v[192:193], v254 offset:4096
    ds_read_b64_tr_b16 v[194:195], v254 offset:4608
    ds_read_b128 v[160:163], v252 offset:0
    ds_read_b128 v[208:211], v253 offset:0
    ds_read_b128 v[176:179], v252 offset:8192
    ds_read_b128 v[224:227], v253 offset:8192
    ds_read_b128 v[168:171], v252 offset:4096
    ds_read_b128 v[216:219], v253 offset:4096
    ds_read_b64_tr_b16 v[148:149], v255 offset:0
    ds_read_b64_tr_b16 v[150:151], v255 offset:512
    ds_read_b64_tr_b16 v[196:197], v255 offset:4096
    ds_read_b64_tr_b16 v[198:199], v255 offset:4608
    ds_read_b64_tr_b16 v[152:153], v254 offset:8192
    ds_read_b64_tr_b16 v[154:155], v254 offset:8704
    ds_read_b64_tr_b16 v[200:201], v254 offset:12288
    ds_read_b64_tr_b16 v[202:203], v254 offset:12800
    ds_read_b64_tr_b16 v[156:157], v255 offset:8192
    ds_read_b64_tr_b16 v[158:159], v255 offset:8704
    ds_read_b64_tr_b16 v[204:205], v255 offset:12288
    ds_read_b64_tr_b16 v[206:207], v255 offset:12800
    s_waitcnt lgkmcnt(12)
    v_mfma_f32_16x16x32_bf16 v[16:19], v[144:147], v[160:163], v[16:19]
    ds_read_b128 v[184:187], v252 offset:12288
    v_mfma_f32_16x16x32_bf16 v[16:19], v[192:195], v[208:211], v[16:19]
    ds_read_b128 v[232:235], v253 offset:12288
    v_mfma_f32_16x16x32_bf16 v[80:83], v[144:147], v[176:179], v[80:83]
    buffer_load_dwordx4 v242, s[20:23], s54 offen offset:2048  lds
    v_mfma_f32_16x16x32_bf16 v[80:83], v[192:195], v[224:227], v[80:83]
    ds_read_b128 v[164:167], v252 offset:2048
    v_mfma_f32_16x16x32_bf16 v[48:51], v[144:147], v[168:171], v[48:51]
    ds_read_b128 v[212:215], v253 offset:2048
    v_mfma_f32_16x16x32_bf16 v[48:51], v[192:195], v[216:219], v[48:51]
    buffer_load_dwordx4 v243, s[20:23], s54 offen offset:3072  lds
    s_waitcnt lgkmcnt(12)
    v_mfma_f32_16x16x32_bf16 v[20:23], v[148:151], v[160:163], v[20:23]
    ds_read_b128 v[180:183], v252 offset:10240
    v_mfma_f32_16x16x32_bf16 v[20:23], v[196:199], v[208:211], v[20:23]
    ds_read_b128 v[228:231], v253 offset:10240
    v_mfma_f32_16x16x32_bf16 v[84:87], v[148:151], v[176:179], v[84:87]
    ds_read_b128 v[172:175], v252 offset:6144
    v_mfma_f32_16x16x32_bf16 v[84:87], v[196:199], v[224:227], v[84:87]
    s_add_u32 m0, s56, 4096
    s_nop 0
    buffer_load_dwordx4 v244, s[20:23], s54 offen offset:0  lds
    v_mfma_f32_16x16x32_bf16 v[52:55], v[148:151], v[168:171], v[52:55]
    ds_read_b128 v[220:223], v253 offset:6144
    v_mfma_f32_16x16x32_bf16 v[52:55], v[196:199], v[216:219], v[52:55]
    ds_read_b128 v[188:191], v252 offset:14336
    s_waitcnt lgkmcnt(13)
    v_mfma_f32_16x16x32_bf16 v[24:27], v[152:155], v[160:163], v[24:27]
    buffer_load_dwordx4 v245, s[20:23], s54 offen offset:1024  lds
    v_mfma_f32_16x16x32_bf16 v[24:27], v[200:203], v[208:211], v[24:27]
    ds_read_b128 v[236:239], v253 offset:14336
    v_mfma_f32_16x16x32_bf16 v[88:91], v[152:155], v[176:179], v[88:91]
    v_mfma_f32_16x16x32_bf16 v[88:91], v[200:203], v[224:227], v[88:91]
    v_mfma_f32_16x16x32_bf16 v[56:59], v[152:155], v[168:171], v[56:59]
    buffer_load_dwordx4 v246, s[20:23], s54 offen offset:2048  lds
    v_mfma_f32_16x16x32_bf16 v[56:59], v[200:203], v[216:219], v[56:59]
    s_waitcnt lgkmcnt(10)
    v_mfma_f32_16x16x32_bf16 v[28:31], v[156:159], v[160:163], v[28:31]
    v_mfma_f32_16x16x32_bf16 v[28:31], v[204:207], v[208:211], v[28:31]
    buffer_load_dwordx4 v247, s[20:23], s54 offen offset:3072  lds
    v_mfma_f32_16x16x32_bf16 v[92:95], v[156:159], v[176:179], v[92:95]
    v_mfma_f32_16x16x32_bf16 v[92:95], v[204:207], v[224:227], v[92:95]
    v_mfma_f32_16x16x32_bf16 v[60:63], v[156:159], v[168:171], v[60:63]
    v_mfma_f32_16x16x32_bf16 v[60:63], v[204:207], v[216:219], v[60:63]
    v_add_u32 v252, 98304, v9
    v_add_u32 v253, 98304, v10
    v_add_u32 v254, 98304, v11
    v_add_u32 v255, 98304, v12
    s_movk_i32 s54, 512
    s_add_u32 s55, s70, 884736
    s_mov_b32 s51, 4
    s_mov_b32 s52, 98304
    s_mov_b32 s53, 49152
    .p2align 3
L_loop:
    s_waitcnt vmcnt(12) lgkmcnt(0)
    s_barrier
    v_mfma_f32_16x16x32_bf16 v[112:115], v[144:147], v[184:187], v[112:115]
    ds_read_b128 v[160:163], v252 offset:0
    v_mfma_f32_16x16x32_bf16 v[112:115], v[192:195], v[232:235], v[112:115]
    s_add_u32 m0, s57, 49152
    ds_read_b128 v[208:211], v253 offset:0
    v_mfma_f32_16x16x32_bf16 v[116:119], v[148:151], v[184:187], v[116:119]
    buffer_load_dwordx4 v248, s[24:27], s55 offen offset:0  lds
    v_mfma_f32_16x16x32_bf16 v[116:119], v[196:199], v[232:235], v[116:119]
    ds_read_b128 v[176:179], v252 offset:8192
    v_mfma_f32_16x16x32_bf16 v[120:123], v[152:155], v[184:187], v[120:123]
    ds_read_b128 v[224:227], v253 offset:8192
    v_mfma_f32_16x16x32_bf16 v[120:123], v[200:203], v[232:235], v[120:123]
    ds_read_b128 v[168:171], v252 offset:4096
    v_mfma_f32_16x16x32_bf16 v[124:127], v[156:159], v[184:187], v[124:127]
    buffer_load_dwordx4 v249, s[24:27], s55 offen offset:1024  lds
    v_mfma_f32_16x16x32_bf16 v[124:127], v[204:207], v[232:235], v[124:127]
    ds_read_b128 v[216:219], v253 offset:4096
    v_mfma_f32_16x16x32_bf16 v[32:35], v[144:147], v[164:167], v[32:35]
    ds_read_b128 v[184:187], v252 offset:12288
    v_mfma_f32_16x16x32_bf16 v[32:35], v[192:195], v[212:215], v[32:35]
    ds_read_b128 v[232:235], v253 offset:12288
    v_mfma_f32_16x16x32_bf16 v[36:39], v[148:151], v[164:167], v[36:39]
    v_mfma_f32_16x16x32_bf16 v[36:39], v[196:199], v[212:215], v[36:39]
    buffer_load_dwordx4 v250, s[24:27], s55 offen offset:2048  lds
    v_mfma_f32_16x16x32_bf16 v[40:43], v[152:155], v[164:167], v[40:43]
    v_mfma_f32_16x16x32_bf16 v[40:43], v[200:203], v[212:215], v[40:43]
    v_mfma_f32_16x16x32_bf16 v[44:47], v[156:159], v[164:167], v[44:47]
    v_mfma_f32_16x16x32_bf16 v[44:47], v[204:207], v[212:215], v[44:47]
    ds_read_b128 v[164:167], v252 offset:2048
    v_mfma_f32_16x16x32_bf16 v[96:99], v[144:147], v[180:183], v[96:99]
    buffer_load_dwordx4 v251, s[24:27], s55 offen offset:3072  lds
    v_mfma_f32_16x16x32_bf16 v[96:99], v[192:195], v[228:231], v[96:99]
    ds_read_b128 v[212:215], v253 offset:2048
    v_mfma_f32_16x16x32_bf16 v[64:67], v[144:147], v[172:175], v[64:67]
    v_mfma_f32_16x16x32_bf16 v[64:67], v[192:195], v[220:223], v[64:67]
    s_add_u32 m0, s56, 49152
    v_mfma_f32_16x16x32_bf16 v[128:131], v[144:147], v[188:191], v[128:131]
    buffer_load_dwordx4 v240, s[20:23], s54 offen offset:0  lds
    v_mfma_f32_16x16x32_bf16 v[128:131], v[192:195], v[236:239], v[128:131]
    ds_read_b64_tr_b16 v[144:145], v254 offset:0
    v_mfma_f32_16x16x32_bf16 v[100:103], v[148:151], v[180:183], v[100:103]
    ds_read_b64_tr_b16 v[146:147], v254 offset:512
    v_mfma_f32_16x16x32_bf16 v[100:103], v[196:199], v[228:231], v[100:103]
    ds_read_b64_tr_b16 v[192:193], v254 offset:4096
    v_mfma_f32_16x16x32_bf16 v[68:71], v[148:151], v[172:175], v[68:71]
    ds_read_b64_tr_b16 v[194:195], v254 offset:4608
    v_mfma_f32_16x16x32_bf16 v[68:71], v[196:199], v[220:223], v[68:71]
    buffer_load_dwordx4 v241, s[20:23], s54 offen offset:1024  lds
    v_mfma_f32_16x16x32_bf16 v[132:135], v[148:151], v[188:191], v[132:135]
    v_mfma_f32_16x16x32_bf16 v[132:135], v[196:199], v[236:239], v[132:135]
    ds_read_b64_tr_b16 v[148:149], v255 offset:0
    v_mfma_f32_16x16x32_bf16 v[104:107], v[152:155], v[180:183], v[104:107]
    ds_read_b64_tr_b16 v[150:151], v255 offset:512
    v_mfma_f32_16x16x32_bf16 v[104:107], v[200:203], v[228:231], v[104:107]
    ds_read_b64_tr_b16 v[196:197], v255 offset:4096
    v_mfma_f32_16x16x32_bf16 v[72:75], v[152:155], v[172:175], v[72:75]
    buffer_load_dwordx4 v242, s[20:23], s54 offen offset:2048  lds
    v_mfma_f32_16x16x32_bf16 v[72:75], v[200:203], v[220:223], v[72:75]
    ds_read_b64_tr_b16 v[198:199], v255 offset:4608
    v_mfma_f32_16x16x32_bf16 v[136:139], v[152:155], v[188:191], v[136:139]
    v_mfma_f32_16x16x32_bf16 v[136:139], v[200:203], v[236:239], v[136:139]
    ds_read_b64_tr_b16 v[152:153], v254 offset:8192
    v_mfma_f32_16x16x32_bf16 v[108:111], v[156:159], v[180:183], v[108:111]
    buffer_load_dwordx4 v243, s[20:23], s54 offen offset:3072  lds
    v_mfma_f32_16x16x32_bf16 v[108:111], v[204:207], v[228:231], v[108:111]
    ds_read_b64_tr_b16 v[154:155], v254 offset:8704
    v_mfma_f32_16x16x32_bf16 v[76:79], v[156:159], v[172:175], v[76:79]
    ds_read_b64_tr_b16 v[200:201], v254 offset:12288
    v_mfma_f32_16x16x32_bf16 v[76:79], v[204:207], v[220:223], v[76:79]
    ds_read_b64_tr_b16 v[202:203], v254 offset:12800
    v_mfma_f32_16x16x32_bf16 v[140:143], v[156:159], v[188:191], v[140:143]
    s_add_u32 m0, m0, 4096
    v_mfma_f32_16x16x32_bf16 v[140:143], v[204:207], v[236:239], v[140:143]
    buffer_load_dwordx4 v244, s[20:23], s54 offen offset:0  lds
    s_waitcnt lgkmcnt(8)
    v_mfma_f32_16x16x32_bf16 v[16:19], v[144:147], v[160:163], v[16:19]
    ds_read_b64_tr_b16 v[156:157], v255 offset:8192
    v_mfma_f32_16x16x32_bf16 v[16:19], v[192:195], v[208:211], v[16:19]
    ds_read_b64_tr_b16 v[158:159], v255 offset:8704
    v_mfma_f32_16x16x32_bf16 v[80:83], v[144:147], v[176:179], v[80:83]
    ds_read_b64_tr_b16 v[204:205], v255 offset:12288
    v_mfma_f32_16x16x32_bf16 v[80:83], v[192:195], v[224:227], v[80:83]
    ds_read_b64_tr_b16 v[206:207], v255 offset:12800
    v_mfma_f32_16x16x32_bf16 v[48:51], v[144:147], v[168:171], v[48:51]
    buffer_load_dwordx4 v245, s[20:23], s54 offen offset:1024  lds
    v_mfma_f32_16x16x32_bf16 v[48:51], v[192:195], v[216:219], v[48:51]
    ds_read_b128 v[180:183], v252 offset:10240
    s_waitcnt lgkmcnt(9)
    v_mfma_f32_16x16x32_bf16 v[20:23], v[148:151], v[160:163], v[20:23]
    ds_read_b128 v[228:231], v253 offset:10240
    v_mfma_f32_16x16x32_bf16 v[20:23], v[196:199], v[208:211], v[20:23]
    ds_read_b128 v[172:175], v252 offset:6144
    v_mfma_f32_16x16x32_bf16 v[84:87], v[148:151], v[176:179], v[84:87]
    buffer_load_dwordx4 v246, s[20:23], s54 offen offset:2048  lds
    v_mfma_f32_16x16x32_bf16 v[84:87], v[196:199], v[224:227], v[84:87]
    ds_read_b128 v[220:223], v253 offset:6144
    v_mfma_f32_16x16x32_bf16 v[52:55], v[148:151], v[168:171], v[52:55]
    ds_read_b128 v[188:191], v252 offset:14336
    v_mfma_f32_16x16x32_bf16 v[52:55], v[196:199], v[216:219], v[52:55]
    ds_read_b128 v[236:239], v253 offset:14336
    s_waitcnt lgkmcnt(10)
    v_mfma_f32_16x16x32_bf16 v[24:27], v[152:155], v[160:163], v[24:27]
    v_add_u32 v252, 0, v9
    v_add_u32 v253, 0, v10
    v_mfma_f32_16x16x32_bf16 v[24:27], v[200:203], v[208:211], v[24:27]
    buffer_load_dwordx4 v247, s[20:23], s54 offen offset:3072  lds
    v_mfma_f32_16x16x32_bf16 v[88:91], v[152:155], v[176:179], v[88:91]
    v_add_u32 v254, 0, v11
    v_add_u32 v255, 0, v12
    v_mfma_f32_16x16x32_bf16 v[88:91], v[200:203], v[224:227], v[88:91]
    s_add_u32 s54, s54, 128
    s_add_u32 s55, s55, 221184
    v_mfma_f32_16x16x32_bf16 v[56:59], v[152:155], v[168:171], v[56:59]
    v_mfma_f32_16x16x32_bf16 v[56:59], v[200:203], v[216:219], v[56:59]
    s_waitcnt lgkmcnt(6)
    v_mfma_f32_16x16x32_bf16 v[28:31], v[156:159], v[160:163], v[28:31]
    v_mfma_f32_16x16x32_bf16 v[28:31], v[204:207], v[208:211], v[28:31]
    v_mfma_f32_16x16x32_bf16 v[92:95], v[156:159], v[176:179], v[92:95]
    v_mfma_f32_16x16x32_bf16 v[92:95], v[204:207], v[224:227], v[92:95]
    v_mfma_f32_16x16x32_bf16 v[60:63], v[156:159], v[168:171], v[60:63]
    v_mfma_f32_16x16x32_bf16 v[60:63], v[204:207], v[216:219], v[60:63]
    s_waitcnt vmcnt(12) lgkmcnt(0)
    s_barrier
    v_mfma_f32_16x16x32_bf16 v[112:115], v[144:147], v[184:187], v[112:115]
    ds_read_b128 v[160:163], v252 offset:0
    v_mfma_f32_16x16x32_bf16 v[112:115], v[192:195], v[232:235], v[112:115]
    s_add_u32 m0, s57, 98304
    ds_read_b128 v[208:211], v253 offset:0
    v_mfma_f32_16x16x32_bf16 v[116:119], v[148:151], v[184:187], v[116:119]
    buffer_load_dwordx4 v248, s[24:27], s55 offen offset:0  lds
    v_mfma_f32_16x16x32_bf16 v[116:119], v[196:199], v[232:235], v[116:119]
    ds_read_b128 v[176:179], v252 offset:8192
    v_mfma_f32_16x16x32_bf16 v[120:123], v[152:155], v[184:187], v[120:123]
    ds_read_b128 v[224:227], v253 offset:8192
    v_mfma_f32_16x16x32_bf16 v[120:123], v[200:203], v[232:235], v[120:123]
    ds_read_b128 v[168:171], v252 offset:4096
    v_mfma_f32_16x16x32_bf16 v[124:127], v[156:159], v[184:187], v[124:127]
    buffer_load_dwordx4 v249, s[24:27], s55 offen offset:1024  lds
    v_mfma_f32_16x16x32_bf16 v[124:127], v[204:207], v[232:235], v[124:127]
    ds_read_b128 v[216:219], v253 offset:4096
    v_mfma_f32_16x16x32_bf16 v[32:35], v[144:147], v[164:167], v[32:35]
    ds_read_b128 v[184:187], v252 offset:12288
    v_mfma_f32_16x16x32_bf16 v[32:35], v[192:195], v[212:215], v[32:35]
    ds_read_b128 v[232:235], v253 offset:12288
    v_mfma_f32_16x16x32_bf16 v[36:39], v[148:151], v[164:167], v[36:39]
    v_mfma_f32_16x16x32_bf16 v[36:39], v[196:199], v[212:215], v[36:39]
    buffer_load_dwordx4 v250, s[24:27], s55 offen offset:2048  lds
    v_mfma_f32_16x16x32_bf16 v[40:43], v[152:155], v[164:167], v[40:43]
    v_mfma_f32_16x16x32_bf16 v[40:43], v[200:203], v[212:215], v[40:43]
    v_mfma_f32_16x16x32_bf16 v[44:47], v[156:159], v[164:167], v[44:47]
    v_mfma_f32_16x16x32_bf16 v[44:47], v[204:207], v[212:215], v[44:47]
    ds_read_b128 v[164:167], v252 offset:2048
    v_mfma_f32_16x16x32_bf16 v[96:99], v[144:147], v[180:183], v[96:99]
    buffer_load_dwordx4 v251, s[24:27], s55 offen offset:3072  lds
    v_mfma_f32_16x16x32_bf16 v[96:99], v[192:195], v[228:231], v[96:99]
    ds_read_b128 v[212:215], v253 offset:2048
    v_mfma_f32_16x16x32_bf16 v[64:67], v[144:147], v[172:175], v[64:67]
    v_mfma_f32_16x16x32_bf16 v[64:67], v[192:195], v[220:223], v[64:67]
    s_add_u32 m0, s56, 98304
    v_mfma_f32_16x16x32_bf16 v[128:131], v[144:147], v[188:191], v[128:131]
    buffer_load_dwordx4 v240, s[20:23], s54 offen offset:0  lds
    v_mfma_f32_16x16x32_bf16 v[128:131], v[192:195], v[236:239], v[128:131]
    ds_read_b64_tr_b16 v[144:145], v254 offset:0
    v_mfma_f32_16x16x32_bf16 v[100:103], v[148:151], v[180:183], v[100:103]
    ds_read_b64_tr_b16 v[146:147], v254 offset:512
    v_mfma_f32_16x16x32_bf16 v[100:103], v[196:199], v[228:231], v[100:103]
    ds_read_b64_tr_b16 v[192:193], v254 offset:4096
    v_mfma_f32_16x16x32_bf16 v[68:71], v[148:151], v[172:175], v[68:71]
    ds_read_b64_tr_b16 v[194:195], v254 offset:4608
    v_mfma_f32_16x16x32_bf16 v[68:71], v[196:199], v[220:223], v[68:71]
    buffer_load_dwordx4 v241, s[20:23], s54 offen offset:1024  lds
    v_mfma_f32_16x16x32_bf16 v[132:135], v[148:151], v[188:191], v[132:135]
    v_mfma_f32_16x16x32_bf16 v[132:135], v[196:199], v[236:239], v[132:135]
    ds_read_b64_tr_b16 v[148:149], v255 offset:0
    v_mfma_f32_16x16x32_bf16 v[104:107], v[152:155], v[180:183], v[104:107]
    ds_read_b64_tr_b16 v[150:151], v255 offset:512
    v_mfma_f32_16x16x32_bf16 v[104:107], v[200:203], v[228:231], v[104:107]
    ds_read_b64_tr_b16 v[196:197], v255 offset:4096
    v_mfma_f32_16x16x32_bf16 v[72:75], v[152:155], v[172:175], v[72:75]
    buffer_load_dwordx4 v242, s[20:23], s54 offen offset:2048  lds
    v_mfma_f32_16x16x32_bf16 v[72:75], v[200:203], v[220:223], v[72:75]
    ds_read_b64_tr_b16 v[198:199], v255 offset:4608
    v_mfma_f32_16x16x32_bf16 v[136:139], v[152:155], v[188:191], v[136:139]
    v_mfma_f32_16x16x32_bf16 v[136:139], v[200:203], v[236:239], v[136:139]
    ds_read_b64_tr_b16 v[152:153], v254 offset:8192
    v_mfma_f32_16x16x32_bf16 v[108:111], v[156:159], v[180:183], v[108:111]
    buffer_load_dwordx4 v243, s[20:23], s54 offen offset:3072  lds
    v_mfma_f32_16x16x32_bf16 v[108:111], v[204:207], v[228:231], v[108:111]
    ds_read_b64_tr_b16 v[154:155], v254 offset:8704
    v_mfma_f32_16x16x32_bf16 v[76:79], v[156:159], v[172:175], v[76:79]
    ds_read_b64_tr_b16 v[200:201], v254 offset:12288
    v_mfma_f32_16x16x32_bf16 v[76:79], v[204:207], v[220:223], v[76:79]
    ds_read_b64_tr_b16 v[202:203], v254 offset:12800
    v_mfma_f32_16x16x32_bf16 v[140:143], v[156:159], v[188:191], v[140:143]
    s_add_u32 m0, m0, 4096
    v_mfma_f32_16x16x32_bf16 v[140:143], v[204:207], v[236:239], v[140:143]
    buffer_load_dwordx4 v244, s[20:23], s54 offen offset:0  lds
    s_waitcnt lgkmcnt(8)
    v_mfma_f32_16x16x32_bf16 v[16:19], v[144:147], v[160:163], v[16:19]
    ds_read_b64_tr_b16 v[156:157], v255 offset:8192
    v_mfma_f32_16x16x32_bf16 v[16:19], v[192:195], v[208:211], v[16:19]
    ds_read_b64_tr_b16 v[158:159], v255 offset:8704
    v_mfma_f32_16x16x32_bf16 v[80:83], v[144:147], v[176:179], v[80:83]
    ds_read_b64_tr_b16 v[204:205], v255 offset:12288
    v_mfma_f32_16x16x32_bf16 v[80:83], v[192:195], v[224:227], v[80:83]
    ds_read_b64_tr_b16 v[206:207], v255 offset:12800
    v_mfma_f32_16x16x32_bf16 v[48:51], v[144:147], v[168:171], v[48:51]
    buffer_load_dwordx4 v245, s[20:23], s54 offen offset:1024  lds
    v_mfma_f32_16x16x32_bf16 v[48:51], v[192:195], v[216:219], v[48:51]
    ds_read_b128 v[180:183], v252 offset:10240
    s_waitcnt lgkmcnt(9)
    v_mfma_f32_16x16x32_bf16 v[20:23], v[148:151], v[160:163], v[20:23]
    ds_read_b128 v[228:231], v253 offset:10240
    v_mfma_f32_16x16x32_bf16 v[20:23], v[196:199], v[208:211], v[20:23]
    ds_read_b128 v[172:175], v252 offset:6144
    v_mfma_f32_16x16x32_bf16 v[84:87], v[148:151], v[176:179], v[84:87]
    buffer_load_dwordx4 v246, s[20:23], s54 offen offset:2048  lds
    v_mfma_f32_16x16x32_bf16 v[84:87], v[196:199], v[224:227], v[84:87]
    ds_read_b128 v[220:223], v253 offset:6144
    v_mfma_f32_16x16x32_bf16 v[52:55], v[148:151], v[168:171], v[52:55]
    ds_read_b128 v[188:191], v252 offset:14336
    v_mfma_f32_16x16x32_bf16 v[52:55], v[196:199], v[216:219], v[52:55]
    ds_read_b128 v[236:239], v253 offset:14336
    s_waitcnt lgkmcnt(10)
    v_mfma_f32_16x16x32_bf16 v[24:27], v[152:155], v[160:163], v[24:27]
    v_add_u32 v252, 49152, v9
    v_add_u32 v253, 49152, v10
    v_mfma_f32_16x16x32_bf16 v[24:27], v[200:203], v[208:211], v[24:27]
    buffer_load_dwordx4 v247, s[20:23], s54 offen offset:3072  lds
    v_mfma_f32_16x16x32_bf16 v[88:91], v[152:155], v[176:179], v[88:91]
    v_add_u32 v254, 49152, v11
    v_add_u32 v255, 49152, v12
    v_mfma_f32_16x16x32_bf16 v[88:91], v[200:203], v[224:227], v[88:91]
    s_add_u32 s54, s54, 128
    s_add_u32 s55, s55, 221184
    v_mfma_f32_16x16x32_bf16 v[56:59], v[152:155], v[168:171], v[56:59]
    v_mfma_f32_16x16x32_bf16 v[56:59], v[200:203], v[216:219], v[56:59]
    s_waitcnt lgkmcnt(6)
    v_mfma_f32_16x16x32_bf16 v[28:31], v[156:159], v[160:163], v[28:31]
    v_mfma_f32_16x16x32_bf16 v[28:31], v[204:207], v[208:211], v[28:31]
    v_mfma_f32_16x16x32_bf16 v[92:95], v[156:159], v[176:179], v[92:95]
    v_mfma_f32_16x16x32_bf16 v[92:95], v[204:207], v[224:227], v[92:95]
    v_mfma_f32_16x16x32_bf16 v[60:63], v[156:159], v[168:171], v[60:63]
    v_mfma_f32_16x16x32_bf16 v[60:63], v[204:207], v[216:219], v[60:63]
    s_waitcnt vmcnt(12) lgkmcnt(0)
    s_barrier
    v_mfma_f32_16x16x32_bf16 v[112:115], v[144:147], v[184:187], v[112:115]
    ds_read_b128 v[160:163], v252 offset:0
    v_mfma_f32_16x16x32_bf16 v[112:115], v[192:195], v[232:235], v[112:115]
    s_add_u32 m0, s57, 0
    ds_read_b128 v[208:211], v253 offset:0
    v_mfma_f32_16x16x32_bf16 v[116:119], v[148:151], v[184:187], v[116:119]
    buffer_load_dwordx4 v248, s[24:27], s55 offen offset:0  lds
    v_mfma_f32_16x16x32_bf16 v[116:119], v[196:199], v[232:235], v[116:119]
    ds_read_b128 v[176:179], v252 offset:8192
    v_mfma_f32_16x16x32_bf16 v[120:123], v[152:155], v[184:187], v[120:123]
    ds_read_b128 v[224:227], v253 offset:8192
    v_mfma_f32_16x16x32_bf16 v[120:123], v[200:203], v[232:235], v[120:123]
    ds_read_b128 v[168:171], v252 offset:4096
    v_mfma_f32_16x16x32_bf16 v[124:127], v[156:159], v[184:187], v[124:127]
    buffer_load_dwordx4 v249, s[24:27], s55 offen offset:1024  lds
    v_mfma_f32_16x16x32_bf16 v[124:127], v[204:207], v[232:235], v[124:127]
    ds_read_b128 v[216:219], v253 offset:4096
    v_mfma_f32_16x16x32_bf16 v[32:35], v[144:147], v[164:167], v[32:35]
    ds_read_b128 v[184:187], v252 offset:12288
    v_mfma_f32_16x16x32_bf16 v[32:35], v[192:195], v[212:215], v[32:35]
    ds_read_b128 v[232:235], v253 offset:12288
    v_mfma_f32_16x16x32_bf16 v[36:39], v[148:151], v[164:167], v[36:39]
    v_mfma_f32_16x16x32_bf16 v[36:39], v[196:199], v[212:215], v[36:39]
    buffer_load_dwordx4 v250, s[24:27], s55 offen offset:2048  lds
    v_mfma_f32_16x16x32_bf16 v[40:43], v[152:155], v[164:167], v[40:43]
    v_mfma_f32_16x16x32_bf16 v[40:43], v[200:203], v[212:215], v[40:43]
    v_mfma_f32_16x16x32_bf16 v[44:47], v[156:159], v[164:167], v[44:47]
    v_mfma_f32_16x16x32_bf16 v[44:47], v[204:207], v[212:215], v[44:47]
    ds_read_b128 v[164:167], v252 offset:2048
    v_mfma_f32_16x16x32_bf16 v[96:99], v[144:147], v[180:183], v[96:99]
    buffer_load_dwordx4 v251, s[24:27], s55 offen offset:3072  lds
    v_mfma_f32_16x16x32_bf16 v[96:99], v[192:195], v[228:231], v[96:99]
    ds_read_b128 v[212:215], v253 offset:2048
    v_mfma_f32_16x16x32_bf16 v[64:67], v[144:147], v[172:175], v[64:67]
    v_mfma_f32_16x16x32_bf16 v[64:67], v[192:195], v[220:223], v[64:67]
    s_add_u32 m0, s56, 0
    v_mfma_f32_16x16x32_bf16 v[128:131], v[144:147], v[188:191], v[128:131]
    buffer_load_dwordx4 v240, s[20:23], s54 offen offset:0  lds
    v_mfma_f32_16x16x32_bf16 v[128:131], v[192:195], v[236:239], v[128:131]
    ds_read_b64_tr_b16 v[144:145], v254 offset:0
    v_mfma_f32_16x16x32_bf16 v[100:103], v[148:151], v[180:183], v[100:103]
    ds_read_b64_tr_b16 v[146:147], v254 offset:512
    v_mfma_f32_16x16x32_bf16 v[100:103], v[196:199], v[228:231], v[100:103]
    ds_read_b64_tr_b16 v[192:193], v254 offset:4096
    v_mfma_f32_16x16x32_bf16 v[68:71], v[148:151], v[172:175], v[68:71]
    ds_read_b64_tr_b16 v[194:195], v254 offset:4608
    v_mfma_f32_16x16x32_bf16 v[68:71], v[196:199], v[220:223], v[68:71]
    buffer_load_dwordx4 v241, s[20:23], s54 offen offset:1024  lds
    v_mfma_f32_16x16x32_bf16 v[132:135], v[148:151], v[188:191], v[132:135]
    v_mfma_f32_16x16x32_bf16 v[132:135], v[196:199], v[236:239], v[132:135]
    ds_read_b64_tr_b16 v[148:149], v255 offset:0
    v_mfma_f32_16x16x32_bf16 v[104:107], v[152:155], v[180:183], v[104:107]
    ds_read_b64_tr_b16 v[150:151], v255 offset:512
    v_mfma_f32_16x16x32_bf16 v[104:107], v[200:203], v[228:231], v[104:107]
    ds_read_b64_tr_b16 v[196:197], v255 offset:4096
    v_mfma_f32_16x16x32_bf16 v[72:75], v[152:155], v[172:175], v[72:75]
    buffer_load_dwordx4 v242, s[20:23], s54 offen offset:2048  lds
    v_mfma_f32_16x16x32_bf16 v[72:75], v[200:203], v[220:223], v[72:75]
    ds_read_b64_tr_b16 v[198:199], v255 offset:4608
    v_mfma_f32_16x16x32_bf16 v[136:139], v[152:155], v[188:191], v[136:139]
    v_mfma_f32_16x16x32_bf16 v[136:139], v[200:203], v[236:239], v[136:139]
    ds_read_b64_tr_b16 v[152:153], v254 offset:8192
    v_mfma_f32_16x16x32_bf16 v[108:111], v[156:159], v[180:183], v[108:111]
    buffer_load_dwordx4 v243, s[20:23], s54 offen offset:3072  lds
    v_mfma_f32_16x16x32_bf16 v[108:111], v[204:207], v[228:231], v[108:111]
    ds_read_b64_tr_b16 v[154:155], v254 offset:8704
    v_mfma_f32_16x16x32_bf16 v[76:79], v[156:159], v[172:175], v[76:79]
    ds_read_b64_tr_b16 v[200:201], v254 offset:12288
    v_mfma_f32_16x16x32_bf16 v[76:79], v[204:207], v[220:223], v[76:79]
    ds_read_b64_tr_b16 v[202:203], v254 offset:12800
    v_mfma_f32_16x16x32_bf16 v[140:143], v[156:159], v[188:191], v[140:143]
    s_add_u32 m0, m0, 4096
    v_mfma_f32_16x16x32_bf16 v[140:143], v[204:207], v[236:239], v[140:143]
    buffer_load_dwordx4 v244, s[20:23], s54 offen offset:0  lds
    s_waitcnt lgkmcnt(8)
    v_mfma_f32_16x16x32_bf16 v[16:19], v[144:147], v[160:163], v[16:19]
    ds_read_b64_tr_b16 v[156:157], v255 offset:8192
    v_mfma_f32_16x16x32_bf16 v[16:19], v[192:195], v[208:211], v[16:19]
    ds_read_b64_tr_b16 v[158:159], v255 offset:8704
    v_mfma_f32_16x16x32_bf16 v[80:83], v[144:147], v[176:179], v[80:83]
    ds_read_b64_tr_b16 v[204:205], v255 offset:12288
    v_mfma_f32_16x16x32_bf16 v[80:83], v[192:195], v[224:227], v[80:83]
    ds_read_b64_tr_b16 v[206:207], v255 offset:12800
    v_mfma_f32_16x16x32_bf16 v[48:51], v[144:147], v[168:171], v[48:51]
    buffer_load_dwordx4 v245, s[20:23], s54 offen offset:1024  lds
    v_mfma_f32_16x16x32_bf16 v[48:51], v[192:195], v[216:219], v[48:51]
    ds_read_b128 v[180:183], v252 offset:10240
    s_waitcnt lgkmcnt(9)
    v_mfma_f32_16x16x32_bf16 v[20:23], v[148:151], v[160:163], v[20:23]
    ds_read_b128 v[228:231], v253 offset:10240
    v_mfma_f32_16x16x32_bf16 v[20:23], v[196:199], v[208:211], v[20:23]
    ds_read_b128 v[172:175], v252 offset:6144
    v_mfma_f32_16x16x32_bf16 v[84:87], v[148:151], v[176:179], v[84:87]
    buffer_load_dwordx4 v246, s[20:23], s54 offen offset:2048  lds
    v_mfma_f32_16x16x32_bf16 v[84:87], v[196:199], v[224:227], v[84:87]
    ds_read_b128 v[220:223], v253 offset:6144
    v_mfma_f32_16x16x32_bf16 v[52:55], v[148:151], v[168:171], v[52:55]
    ds_read_b128 v[188:191], v252 offset:14336
    v_mfma_f32_16x16x32_bf16 v[52:55], v[196:199], v[216:219], v[52:55]
    ds_read_b128 v[236:239], v253 offset:14336
    s_waitcnt lgkmcnt(10)
    v_mfma_f32_16x16x32_bf16 v[24:27], v[152:155], v[160:163], v[24:27]
    v_add_u32 v252, 98304, v9
    v_add_u32 v253, 98304, v10
    v_mfma_f32_16x16x32_bf16 v[24:27], v[200:203], v[208:211], v[24:27]
    buffer_load_dwordx4 v247, s[20:23], s54 offen offset:3072  lds
    v_mfma_f32_16x16x32_bf16 v[88:91], v[152:155], v[176:179], v[88:91]
    v_add_u32 v254, 98304, v11
    v_add_u32 v255, 98304, v12
    v_mfma_f32_16x16x32_bf16 v[88:91], v[200:203], v[224:227], v[88:91]
    s_add_u32 s54, s54, 128
    s_add_u32 s55, s55, 221184
    v_mfma_f32_16x16x32_bf16 v[56:59], v[152:155], v[168:171], v[56:59]
    s_cmp_lt_u32 s54, 1280
    v_mfma_f32_16x16x32_bf16 v[56:59], v[200:203], v[216:219], v[56:59]
    s_waitcnt lgkmcnt(6)
    v_mfma_f32_16x16x32_bf16 v[28:31], v[156:159], v[160:163], v[28:31]
    v_mfma_f32_16x16x32_bf16 v[28:31], v[204:207], v[208:211], v[28:31]
    v_mfma_f32_16x16x32_bf16 v[92:95], v[156:159], v[176:179], v[92:95]
    v_mfma_f32_16x16x32_bf16 v[92:95], v[204:207], v[224:227], v[92:95]
    v_mfma_f32_16x16x32_bf16 v[60:63], v[156:159], v[168:171], v[60:63]
    v_mfma_f32_16x16x32_bf16 v[60:63], v[204:207], v[216:219], v[60:63]
    s_cbranch_scc1 L_loop
    s_waitcnt vmcnt(12) lgkmcnt(0)
    s_barrier
    s_branch L_pgi8
    .p2align 12
L_iti8:
    s_branch L_itbi8
L_pgi8:
    v_mfma_f32_16x16x32_bf16 v[112:115], v[144:147], v[184:187], v[112:115]
    ds_read_b128 v[160:163], v252 offset:0
    v_add_u32 v251, 9216, v2
    v_mfma_f32_16x16x32_bf16 v[112:115], v[192:195], v[232:235], v[112:115]
    s_add_u32 m0, s69, 49152
    s_mov_b32 s66, 0
    ds_read_b128 v[208:211], v253 offset:0
    v_mfma_f32_16x16x32_bf16 v[116:119], v[148:151], v[184:187], v[116:119]
    buffer_load_dwordx4 v2, s[32:35], s66 offen lds
    v_mfma_f32_16x16x32_bf16 v[116:119], v[196:199], v[232:235], v[116:119]
    ds_read_b128 v[176:179], v252 offset:8192
    v_add_u32 v1, 49152, v3
    v_mfma_f32_16x16x32_bf16 v[120:123], v[152:155], v[184:187], v[120:123]
    ds_read_b128 v[224:227], v253 offset:8192
    v_mfma_f32_16x16x32_bf16 v[120:123], v[200:203], v[232:235], v[120:123]
    ds_read_b128 v[168:171], v252 offset:4096
    v_mfma_f32_16x16x32_bf16 v[124:127], v[156:159], v[184:187], v[124:127]
    buffer_load_dwordx4 v251, s[32:35], s66 offen offset:1024 lds
    v_mfma_f32_16x16x32_bf16 v[124:127], v[204:207], v[232:235], v[124:127]
    ds_read_b128 v[216:219], v253 offset:4096
    v_mfma_f32_16x16x32_bf16 v[32:35], v[144:147], v[164:167], v[32:35]
    ds_read_b128 v[184:187], v252 offset:12288
    v_mfma_f32_16x16x32_bf16 v[32:35], v[192:195], v[212:215], v[32:35]
    s_add_u32 m0, s69, 57344
    s_mov_b32 s66, 20480
    ds_read_b128 v[232:235], v253 offset:12288
    v_mfma_f32_16x16x32_bf16 v[36:39], v[148:151], v[164:167], v[36:39]
    buffer_load_dwordx4 v2, s[32:35], s66 offen lds
    v_mfma_f32_16x16x32_bf16 v[36:39], v[196:199], v[212:215], v[36:39]
    v_xor_b32 v4, 32, v1
    v_mfma_f32_16x16x32_bf16 v[40:43], v[152:155], v[164:167], v[40:43]
    v_xor_b32 v6, 64, v1
    v_mfma_f32_16x16x32_bf16 v[40:43], v[200:203], v[212:215], v[40:43]
    v_xor_b32 v250, 96, v1
    v_mfma_f32_16x16x32_bf16 v[44:47], v[156:159], v[164:167], v[44:47]
    buffer_load_dwordx4 v251, s[32:35], s66 offen offset:1024 lds
    v_mfma_f32_16x16x32_bf16 v[44:47], v[204:207], v[212:215], v[44:47]
    ds_read_b128 v[164:167], v252 offset:2048
    v_mfma_f32_16x16x32_bf16 v[96:99], v[144:147], v[180:183], v[96:99]
    ds_read_b128 v[212:215], v253 offset:2048
    v_mfma_f32_16x16x32_bf16 v[96:99], v[192:195], v[228:231], v[96:99]
    s_add_u32 m0, s69, 65536
    s_mov_b32 s66, 40960
    v_mfma_f32_16x16x32_bf16 v[64:67], v[144:147], v[172:175], v[64:67]
    buffer_load_dwordx4 v2, s[32:35], s66 offen lds
    v_mfma_f32_16x16x32_bf16 v[64:67], v[192:195], v[220:223], v[64:67]
    buffer_load_dword v14, off, s[40:43], 0 sc1
    v_mfma_f32_16x16x32_bf16 v[128:131], v[144:147], v[188:191], v[128:131]
    v_mfma_f32_16x16x32_bf16 v[128:131], v[192:195], v[236:239], v[128:131]
    ds_read_b64_tr_b16 v[144:145], v254 offset:0
    v_mfma_f32_16x16x32_bf16 v[100:103], v[148:151], v[180:183], v[100:103]
    buffer_load_dwordx4 v251, s[32:35], s66 offen offset:1024 lds
    v_mfma_f32_16x16x32_bf16 v[100:103], v[196:199], v[228:231], v[100:103]
    ds_read_b64_tr_b16 v[146:147], v254 offset:512
    v_mfma_f32_16x16x32_bf16 v[68:71], v[148:151], v[172:175], v[68:71]
    ds_read_b64_tr_b16 v[192:193], v254 offset:4096
    v_mfma_f32_16x16x32_bf16 v[68:71], v[196:199], v[220:223], v[68:71]
    s_add_u32 m0, s69, 73728
    s_mov_b32 s66, 61440
    ds_read_b64_tr_b16 v[194:195], v254 offset:4608
    v_mfma_f32_16x16x32_bf16 v[132:135], v[148:151], v[188:191], v[132:135]
    buffer_load_dwordx4 v2, s[32:35], s66 offen lds
    v_mfma_f32_16x16x32_bf16 v[132:135], v[196:199], v[236:239], v[132:135]
    ds_read_b64_tr_b16 v[148:149], v255 offset:0
    v_mfma_f32_16x16x32_bf16 v[104:107], v[152:155], v[180:183], v[104:107]
    ds_read_b64_tr_b16 v[150:151], v255 offset:512
    v_mfma_f32_16x16x32_bf16 v[104:107], v[200:203], v[228:231], v[104:107]
    ds_read_b64_tr_b16 v[196:197], v255 offset:4096
    v_mfma_f32_16x16x32_bf16 v[72:75], v[152:155], v[172:175], v[72:75]
    buffer_load_dwordx4 v251, s[32:35], s66 offen offset:1024 lds
    v_mfma_f32_16x16x32_bf16 v[72:75], v[200:203], v[220:223], v[72:75]
    ds_read_b64_tr_b16 v[198:199], v255 offset:4608
    v_mfma_f32_16x16x32_bf16 v[136:139], v[152:155], v[188:191], v[136:139]
    v_mfma_f32_16x16x32_bf16 v[136:139], v[200:203], v[236:239], v[136:139]
    s_add_u32 m0, s69, 81920
    s_mov_b32 s66, 81920
    ds_read_b64_tr_b16 v[152:153], v254 offset:8192
    v_mfma_f32_16x16x32_bf16 v[108:111], v[156:159], v[180:183], v[108:111]
    buffer_load_dwordx4 v2, s[32:35], s66 offen lds
    v_mfma_f32_16x16x32_bf16 v[108:111], v[204:207], v[228:231], v[108:111]
    ds_read_b64_tr_b16 v[154:155], v254 offset:8704
    v_mfma_f32_16x16x32_bf16 v[76:79], v[156:159], v[172:175], v[76:79]
    ds_read_b64_tr_b16 v[200:201], v254 offset:12288
    v_mfma_f32_16x16x32_bf16 v[76:79], v[204:207], v[220:223], v[76:79]
    ds_read_b64_tr_b16 v[202:203], v254 offset:12800
    v_mfma_f32_16x16x32_bf16 v[140:143], v[156:159], v[188:191], v[140:143]
    buffer_load_dwordx4 v251, s[32:35], s66 offen offset:1024 lds
    v_mfma_f32_16x16x32_bf16 v[140:143], v[204:207], v[236:239], v[140:143]
    ds_read_b64_tr_b16 v[156:157], v255 offset:8192
    s_waitcnt lgkmcnt(9)
    v_mfma_f32_16x16x32_bf16 v[16:19], v[144:147], v[160:163], v[16:19]
    ds_read_b64_tr_b16 v[158:159], v255 offset:8704
    v_mfma_f32_16x16x32_bf16 v[16:19], v[192:195], v[208:211], v[16:19]
    s_add_u32 m0, s69, 90112
    s_mov_b32 s66, 102400
    ds_read_b64_tr_b16 v[204:205], v255 offset:12288
    v_mfma_f32_16x16x32_bf16 v[80:83], v[144:147], v[176:179], v[80:83]
    buffer_load_dwordx4 v2, s[32:35], s66 offen lds
    v_mfma_f32_16x16x32_bf16 v[80:83], v[192:195], v[224:227], v[80:83]
    ds_read_b64_tr_b16 v[206:207], v255 offset:12800
    v_mfma_f32_16x16x32_bf16 v[48:51], v[144:147], v[168:171], v[48:51]
    ds_read_b128 v[180:183], v252 offset:10240
    v_mfma_f32_16x16x32_bf16 v[48:51], v[192:195], v[216:219], v[48:51]
    ds_read_b128 v[228:231], v253 offset:10240
    s_waitcnt lgkmcnt(10)
    v_mfma_f32_16x16x32_bf16 v[20:23], v[148:151], v[160:163], v[20:23]
    buffer_load_dwordx4 v251, s[32:35], s66 offen offset:1024 lds
    v_mfma_f32_16x16x32_bf16 v[20:23], v[196:199], v[208:211], v[20:23]
    ds_read_b128 v[172:175], v252 offset:6144
    v_mfma_f32_16x16x32_bf16 v[84:87], v[148:151], v[176:179], v[84:87]
    ds_read_b128 v[220:223], v253 offset:6144
    v_mfma_f32_16x16x32_bf16 v[84:87], v[196:199], v[224:227], v[84:87]
    s_add_u32 m0, s69, 147456
    s_mov_b32 s66, 122880
    ds_read_b128 v[188:191], v252 offset:14336
    v_mfma_f32_16x16x32_bf16 v[52:55], v[148:151], v[168:171], v[52:55]
    buffer_load_dwordx4 v2, s[32:35], s66 offen lds
    v_mfma_f32_16x16x32_bf16 v[52:55], v[196:199], v[216:219], v[52:55]
    ds_read_b128 v[236:239], v253 offset:14336
    s_waitcnt lgkmcnt(10)
    v_mfma_f32_16x16x32_bf16 v[24:27], v[152:155], v[160:163], v[24:27]
    v_add_u32 v252, 0, v9
    v_add_u32 v253, 0, v10
    v_mfma_f32_16x16x32_bf16 v[24:27], v[200:203], v[208:211], v[24:27]
    v_add_u32 v254, 0, v11
    v_add_u32 v255, 0, v12
    v_mfma_f32_16x16x32_bf16 v[88:91], v[152:155], v[176:179], v[88:91]
    buffer_load_dwordx4 v251, s[32:35], s66 offen offset:1024 lds
    v_mfma_f32_16x16x32_bf16 v[88:91], v[200:203], v[224:227], v[88:91]
    v_mov_b32 v248, 0xbdd2d3e8
    v_mov_b32 v249, 0xbdd2d3e8
    v_mfma_f32_16x16x32_bf16 v[56:59], v[152:155], v[168:171], v[56:59]
    v_xor_b32 v9, 32, v3
    v_xor_b32 v10, 64, v3
    v_mfma_f32_16x16x32_bf16 v[56:59], v[200:203], v[216:219], v[56:59]
    v_xor_b32 v11, 96, v3
    s_waitcnt lgkmcnt(6)
    v_mfma_f32_16x16x32_bf16 v[28:31], v[156:159], v[160:163], v[28:31]
    v_mfma_f32_16x16x32_bf16 v[28:31], v[204:207], v[208:211], v[28:31]
    v_mfma_f32_16x16x32_bf16 v[92:95], v[156:159], v[176:179], v[92:95]
    v_mfma_f32_16x16x32_bf16 v[92:95], v[204:207], v[224:227], v[92:95]
    v_mfma_f32_16x16x32_bf16 v[60:63], v[156:159], v[168:171], v[60:63]
    v_mfma_f32_16x16x32_bf16 v[60:63], v[204:207], v[216:219], v[60:63]
    s_waitcnt vmcnt(15) lgkmcnt(0)
    s_barrier
    v_mfma_f32_16x16x32_bf16 v[112:115], v[144:147], v[184:187], v[112:115]
    ds_read_b64_tr_b16 a[192:193], v254 offset:0
    ds_read_b64_tr_b16 a[194:195], v254 offset:512
    v_mfma_f32_16x16x32_bf16 v[112:115], v[192:195], v[232:235], v[112:115]
    ds_read_b64_tr_b16 a[208:209], v254 offset:4096
    ds_read_b64_tr_b16 a[210:211], v254 offset:4608
    v_mfma_f32_16x16x32_bf16 v[116:119], v[148:151], v[184:187], v[116:119]
    ds_read_b64_tr_b16 a[196:197], v255 offset:0
    ds_read_b64_tr_b16 a[198:199], v255 offset:512
    v_mfma_f32_16x16x32_bf16 v[116:119], v[196:199], v[232:235], v[116:119]
    ds_read_b64_tr_b16 a[212:213], v255 offset:4096
    ds_read_b64_tr_b16 a[214:215], v255 offset:4608
    v_mfma_f32_16x16x32_bf16 v[120:123], v[152:155], v[184:187], v[120:123]
    ds_read_b128 v[160:163], v252 offset:0
    ds_read_b128 v[208:211], v253 offset:0
    v_mfma_f32_16x16x32_bf16 v[120:123], v[200:203], v[232:235], v[120:123]
    ds_read_b64_tr_b16 a[200:201], v254 offset:8192
    ds_read_b64_tr_b16 a[202:203], v254 offset:8704
    v_mfma_f32_16x16x32_bf16 v[124:127], v[156:159], v[184:187], v[124:127]
    ds_read_b64_tr_b16 a[216:217], v254 offset:12288
    ds_read_b64_tr_b16 a[218:219], v254 offset:12800
    v_mfma_f32_16x16x32_bf16 v[124:127], v[204:207], v[232:235], v[124:127]
    ds_read_b64_tr_b16 a[204:205], v255 offset:8192
    ds_read_b64_tr_b16 a[206:207], v255 offset:8704
    v_mfma_f32_16x16x32_bf16 v[32:35], v[144:147], v[164:167], v[32:35]
    ds_read_b64_tr_b16 a[220:221], v255 offset:12288
    ds_read_b64_tr_b16 a[222:223], v255 offset:12800
    v_mfma_f32_16x16x32_bf16 v[32:35], v[192:195], v[212:215], v[32:35]
    ds_read_b128 v[176:179], v252 offset:8192
    ds_read_b128 v[224:227], v253 offset:8192
    v_mfma_f32_16x16x32_bf16 v[36:39], v[148:151], v[164:167], v[36:39]
    ds_read_b128 v[168:171], v252 offset:4096
    ds_read_b128 v[216:219], v253 offset:4096
    v_mfma_f32_16x16x32_bf16 v[36:39], v[196:199], v[212:215], v[36:39]
    s_add_u32 m0, s69, 98304
    s_mov_b32 s66, 143360
    v_mfma_f32_16x16x32_bf16 v[40:43], v[152:155], v[164:167], v[40:43]
    buffer_load_dwordx4 v2, s[32:35], s66 offen lds
    v_mfma_f32_16x16x32_bf16 v[40:43], v[200:203], v[212:215], v[40:43]
    buffer_load_dwordx4 v251, s[32:35], s66 offen offset:1024 lds
    v_mfma_f32_16x16x32_bf16 v[44:47], v[156:159], v[164:167], v[44:47]
    s_waitcnt vmcnt(15)
    ds_read_b64_tr_b16 a[0:1], v3 offset:0
    v_mfma_f32_16x16x32_bf16 v[44:47], v[204:207], v[212:215], v[44:47]
    ds_read_b64_tr_b16 a[4:5], v9 offset:0
    s_waitcnt lgkmcnt(6)
    v_mfma_f32_16x16x32_bf16 v[16:19], a[192:195], v[160:163], v[16:19]
    ds_read_b64_tr_b16 a[8:9], v10 offset:0
    v_mfma_f32_16x16x32_bf16 v[16:19], a[208:211], v[208:211], v[16:19]
    s_add_u32 m0, s69, 106496
    s_mov_b32 s66, 163840
    v_mfma_f32_16x16x32_bf16 v[20:23], a[196:199], v[160:163], v[20:23]
    buffer_load_dwordx4 v2, s[32:35], s66 offen lds
    v_mfma_f32_16x16x32_bf16 v[20:23], a[212:215], v[208:211], v[20:23]
    buffer_load_dwordx4 v251, s[32:35], s66 offen offset:1024 lds
    v_mfma_f32_16x16x32_bf16 v[24:27], a[200:203], v[160:163], v[24:27]
    ds_read_b64_tr_b16 a[12:13], v11 offset:0
    v_mfma_f32_16x16x32_bf16 v[24:27], a[216:219], v[208:211], v[24:27]
    s_waitcnt vmcnt(15)
    ds_read_b64_tr_b16 a[2:3], v3 offset:8192
    v_mfma_f32_16x16x32_bf16 v[28:31], a[204:207], v[160:163], v[28:31]
    ds_read_b64_tr_b16 a[6:7], v9 offset:8192
    v_mfma_f32_16x16x32_bf16 v[28:31], a[220:223], v[208:211], v[28:31]
    ds_read_b64_tr_b16 a[10:11], v10 offset:8192
    ds_read_b64_tr_b16 a[14:15], v11 offset:8192
    s_waitcnt vmcnt(13)
    v_cmp_eq_u32 vcc, 1, v14
    s_cmp_eq_u64 vcc, 0
    s_cbranch_scc1 L_slow1
L_back1:
    s_nop 3
L_tile0:
    v_pk_mul_f32 v[240:241], v[16:17], v[16:17]
    v_pk_mul_f32 v[242:243], v[18:19], v[18:19]
    v_pk_mul_f32 v[244:245], v[20:21], v[20:21]
    v_pk_mul_f32 v[246:247], v[22:23], v[22:23]
    v_pk_fma_f32 v[240:241], v[240:241], v[248:249], s[18:19]
    v_pk_fma_f32 v[242:243], v[242:243], v[248:249], s[18:19]
    s_mov_b32 s66, 184320
    v_pk_fma_f32 v[244:245], v[244:245], v[248:249], s[18:19]
    v_pk_fma_f32 v[246:247], v[246:247], v[248:249], s[18:19]
    s_add_u32 m0, s69, 114688
    v_pk_mul_f32 v[240:241], v[240:241], v[16:17]
    v_pk_mul_f32 v[242:243], v[242:243], v[18:19]
    v_pk_mul_f32 v[244:245], v[244:245], v[20:21]
    v_pk_mul_f32 v[246:247], v[246:247], v[22:23]
    s_waitcnt lgkmcnt(0)
    v_pk_mul_f32 v[16:17], v[16:17], v[24:25]
    v_pk_mul_f32 v[18:19], v[18:19], v[26:27]
    v_pk_mul_f32 v[20:21], v[20:21], v[28:29]
    v_pk_mul_f32 v[22:23], v[22:23], v[30:31]
    v_mfma_f32_16x16x32_bf16 v[96:99], v[144:147], v[180:183], v[96:99]
    ds_read_b128 v[184:187], v252 offset:12288
    v_exp_f32 v240, v240
    v_mfma_f32_16x16x32_bf16 v[96:99], v[192:195], v[228:231], v[96:99]
    ds_read_b128 v[232:235], v253 offset:12288
    v_exp_f32 v241, v241
    v_mfma_f32_16x16x32_bf16 v[100:103], v[148:151], v[180:183], v[100:103]
    s_waitcnt vmcnt(12)
    ds_read_b64_tr_b16 a[16:17], v3 offset:16384
    v_exp_f32 v242, v242
    v_mfma_f32_16x16x32_bf16 v[100:103], v[196:199], v[228:231], v[100:103]
    ds_read_b64_tr_b16 a[20:21], v9 offset:16384
    v_exp_f32 v243, v243
    v_mfma_f32_16x16x32_bf16 v[80:83], a[192:195], v[176:179], v[80:83]
    ds_read_b64_tr_b16 a[24:25], v10 offset:16384
    v_exp_f32 v244, v244
    v_mfma_f32_16x16x32_bf16 v[80:83], a[208:211], v[224:227], v[80:83]
    buffer_load_dwordx4 v2, s[32:35], s66 offen lds
    v_exp_f32 v245, v245
    v_exp_f32 v246, v246
    v_exp_f32 v247, v247
    v_pk_add_f32 v[240:241], v[240:241], 1.0 op_sel_hi:[1,0]
    v_pk_add_f32 v[242:243], v[242:243], 1.0 op_sel_hi:[1,0]
    v_pk_add_f32 v[244:245], v[244:245], 1.0 op_sel_hi:[1,0]
    v_pk_add_f32 v[246:247], v[246:247], 1.0 op_sel_hi:[1,0]
    v_mfma_f32_16x16x32_bf16 v[84:87], a[196:199], v[176:179], v[84:87]
    ds_read_b64_tr_b16 a[28:29], v11 offset:16384
    v_rcp_f32 v240, v240
    v_mfma_f32_16x16x32_bf16 v[84:87], a[212:215], v[224:227], v[84:87]
    s_waitcnt vmcnt(11)
    ds_read_b64_tr_b16 a[18:19], v3 offset:24576
    v_rcp_f32 v241, v241
    v_mfma_f32_16x16x32_bf16 v[88:91], a[200:203], v[176:179], v[88:91]
    buffer_load_dwordx4 v251, s[32:35], s66 offen offset:1024 lds
    v_rcp_f32 v242, v242
    v_mfma_f32_16x16x32_bf16 v[88:91], a[216:219], v[224:227], v[88:91]
    s_add_u32 m0, s69, 122880
    v_rcp_f32 v243, v243
    v_mfma_f32_16x16x32_bf16 v[92:95], a[204:207], v[176:179], v[92:95]
    s_mov_b32 s66, 204800
    v_rcp_f32 v244, v244
    v_mfma_f32_16x16x32_bf16 v[92:95], a[220:223], v[224:227], v[92:95]
    buffer_load_dwordx4 v2, s[32:35], s66 offen lds
    v_rcp_f32 v245, v245
    v_rcp_f32 v246, v246
    v_rcp_f32 v247, v247
    ds_read_b64_tr_b16 a[22:23], v9 offset:24576
    ds_read_b64_tr_b16 a[26:27], v10 offset:24576
    ds_read_b64_tr_b16 a[30:31], v11 offset:24576
    v_pk_mul_f32 v[16:17], v[16:17], v[240:241]
    v_pk_mul_f32 v[18:19], v[18:19], v[242:243]
    v_pk_mul_f32 v[20:21], v[20:21], v[244:245]
    v_pk_mul_f32 v[22:23], v[22:23], v[246:247]
    v_cvt_pk_bf16_f32 v24, v16, v17
    v_cvt_pk_bf16_f32 v25, v18, v19
    v_cvt_pk_bf16_f32 v26, v20, v21
    v_cvt_pk_bf16_f32 v27, v22, v23
L_tile1:
    v_pk_mul_f32 v[240:241], v[80:81], v[80:81]
    v_pk_mul_f32 v[242:243], v[82:83], v[82:83]
    v_pk_mul_f32 v[244:245], v[84:85], v[84:85]
    buffer_load_dwordx4 v251, s[32:35], s66 offen offset:1024 lds
    v_pk_mul_f32 v[246:247], v[86:87], v[86:87]
    v_pk_fma_f32 v[240:241], v[240:241], v[248:249], s[18:19]
    v_pk_fma_f32 v[242:243], v[242:243], v[248:249], s[18:19]
    s_mov_b32 s66, 225280
    v_pk_fma_f32 v[244:245], v[244:245], v[248:249], s[18:19]
    v_pk_fma_f32 v[246:247], v[246:247], v[248:249], s[18:19]
    s_add_u32 m0, s69, 131072
    v_pk_mul_f32 v[240:241], v[240:241], v[80:81]
    v_pk_mul_f32 v[242:243], v[242:243], v[82:83]
    v_pk_mul_f32 v[244:245], v[244:245], v[84:85]
    v_pk_mul_f32 v[246:247], v[246:247], v[86:87]
    s_waitcnt lgkmcnt(0)
    v_pk_mul_f32 v[80:81], v[80:81], v[88:89]
    v_pk_mul_f32 v[82:83], v[82:83], v[90:91]
    v_pk_mul_f32 v[84:85], v[84:85], v[92:93]
    v_pk_mul_f32 v[86:87], v[86:87], v[94:95]
    v_mfma_f32_16x16x32_bf16 v[104:107], v[152:155], v[180:183], v[104:107]
    s_add_u32 s67, s61, 0
    buffer_store_dwordx4 v[24:27], v13, s[28:31], s67 offen sc1
    v_exp_f32 v240, v240
    v_mfma_f32_16x16x32_bf16 v[104:107], v[200:203], v[228:231], v[104:107]
    ds_read_b128 v[164:167], v252 offset:2048
    v_exp_f32 v241, v241
    v_mfma_f32_16x16x32_bf16 v[108:111], v[156:159], v[180:183], v[108:111]
    ds_read_b128 v[212:215], v253 offset:2048
    v_exp_f32 v242, v242
    v_mfma_f32_16x16x32_bf16 v[108:111], v[204:207], v[228:231], v[108:111]
    s_waitcnt vmcnt(13)
    ds_read_b64_tr_b16 a[32:33], v3 offset:32768
    v_exp_f32 v243, v243
    v_mfma_f32_16x16x32_bf16 v[48:51], a[192:195], v[168:171], v[48:51]
    ds_read_b64_tr_b16 a[36:37], v9 offset:32768
    v_exp_f32 v244, v244
    v_mfma_f32_16x16x32_bf16 v[48:51], a[208:211], v[216:219], v[48:51]
    buffer_load_dwordx4 v2, s[32:35], s66 offen lds
    v_exp_f32 v245, v245
    v_exp_f32 v246, v246
    v_exp_f32 v247, v247
    v_pk_add_f32 v[240:241], v[240:241], 1.0 op_sel_hi:[1,0]
    v_pk_add_f32 v[242:243], v[242:243], 1.0 op_sel_hi:[1,0]
    v_pk_add_f32 v[244:245], v[244:245], 1.0 op_sel_hi:[1,0]
    v_pk_add_f32 v[246:247], v[246:247], 1.0 op_sel_hi:[1,0]
    v_mfma_f32_16x16x32_bf16 v[52:55], a[196:199], v[168:171], v[52:55]
    ds_read_b64_tr_b16 a[40:41], v10 offset:32768
    v_rcp_f32 v240, v240
    v_mfma_f32_16x16x32_bf16 v[52:55], a[212:215], v[216:219], v[52:55]
    ds_read_b64_tr_b16 a[44:45], v11 offset:32768
    v_rcp_f32 v241, v241
    v_mfma_f32_16x16x32_bf16 v[56:59], a[200:203], v[168:171], v[56:59]
    buffer_load_dwordx4 v251, s[32:35], s66 offen offset:1024 lds
    v_rcp_f32 v242, v242
    v_mfma_f32_16x16x32_bf16 v[56:59], a[216:219], v[216:219], v[56:59]
    s_add_u32 m0, s69, 139264
    v_rcp_f32 v243, v243
    v_mfma_f32_16x16x32_bf16 v[60:63], a[204:207], v[168:171], v[60:63]
    s_mov_b32 s66, 245760
    v_rcp_f32 v244, v244
    v_mfma_f32_16x16x32_bf16 v[60:63], a[220:223], v[216:219], v[60:63]
    buffer_load_dwordx4 v2, s[32:35], s66 offen lds
    v_rcp_f32 v245, v245
    v_rcp_f32 v246, v246
    v_rcp_f32 v247, v247
    v_pk_mul_f32 v[80:81], v[80:81], v[240:241]
    v_pk_mul_f32 v[82:83], v[82:83], v[242:243]
    v_pk_mul_f32 v[84:85], v[84:85], v[244:245]
    v_pk_mul_f32 v[86:87], v[86:87], v[246:247]
    v_cvt_pk_bf16_f32 v88, v80, v81
    v_cvt_pk_bf16_f32 v89, v82, v83
    v_cvt_pk_bf16_f32 v90, v84, v85
    v_cvt_pk_bf16_f32 v91, v86, v87
L_tile2:
    v_pk_mul_f32 v[240:241], v[48:49], v[48:49]
    v_pk_mul_f32 v[242:243], v[50:51], v[50:51]
    v_pk_mul_f32 v[244:245], v[52:53], v[52:53]
    buffer_load_dwordx4 v251, s[32:35], s66 offen offset:1024 lds
    v_pk_mul_f32 v[246:247], v[54:55], v[54:55]
    v_pk_fma_f32 v[240:241], v[240:241], v[248:249], s[18:19]
    v_pk_fma_f32 v[242:243], v[242:243], v[248:249], s[18:19]
    s_mov_b32 s66, 266240
    v_pk_fma_f32 v[244:245], v[244:245], v[248:249], s[18:19]
    v_pk_fma_f32 v[246:247], v[246:247], v[248:249], s[18:19]
    s_add_u32 m0, s69, 155648
    v_pk_mul_f32 v[240:241], v[240:241], v[48:49]
    v_pk_mul_f32 v[242:243], v[242:243], v[50:51]
    v_pk_mul_f32 v[244:245], v[244:245], v[52:53]
    v_pk_mul_f32 v[246:247], v[246:247], v[54:55]
    s_waitcnt lgkmcnt(0)
    v_pk_mul_f32 v[48:49], v[48:49], v[56:57]
    v_pk_mul_f32 v[50:51], v[50:51], v[58:59]
    v_pk_mul_f32 v[52:53], v[52:53], v[60:61]
    v_pk_mul_f32 v[54:55], v[54:55], v[62:63]
    v_mfma_f32_16x16x32_bf16 v[64:67], v[144:147], v[172:175], v[64:67]
    s_add_u32 s67, s61, 221184
    buffer_store_dwordx4 v[88:91], v13, s[28:31], s67 offen sc1
    v_exp_f32 v240, v240
    v_mfma_f32_16x16x32_bf16 v[64:67], v[192:195], v[220:223], v[64:67]
    ds_read_b128 v[180:183], v252 offset:10240
    v_exp_f32 v241, v241
    v_mfma_f32_16x16x32_bf16 v[68:71], v[148:151], v[172:175], v[68:71]
    ds_read_b128 v[228:231], v253 offset:10240
    v_exp_f32 v242, v242
    v_mfma_f32_16x16x32_bf16 v[68:71], v[196:199], v[220:223], v[68:71]
    s_waitcnt vmcnt(16)
    ds_read_b64_tr_b16 a[34:35], v3 offset:40960
    v_exp_f32 v243, v243
    v_mfma_f32_16x16x32_bf16 v[112:115], a[192:195], v[184:187], v[112:115]
    ds_read_b64_tr_b16 a[38:39], v9 offset:40960
    v_exp_f32 v244, v244
    v_mfma_f32_16x16x32_bf16 v[112:115], a[208:211], v[232:235], v[112:115]
    buffer_load_dwordx4 v2, s[32:35], s66 offen lds
    v_exp_f32 v245, v245
    v_exp_f32 v246, v246
    v_exp_f32 v247, v247
    v_pk_add_f32 v[240:241], v[240:241], 1.0 op_sel_hi:[1,0]
    v_pk_add_f32 v[242:243], v[242:243], 1.0 op_sel_hi:[1,0]
    v_pk_add_f32 v[244:245], v[244:245], 1.0 op_sel_hi:[1,0]
    v_pk_add_f32 v[246:247], v[246:247], 1.0 op_sel_hi:[1,0]
    v_mfma_f32_16x16x32_bf16 v[116:119], a[196:199], v[184:187], v[116:119]
    ds_read_b64_tr_b16 a[42:43], v10 offset:40960
    v_rcp_f32 v240, v240
    v_mfma_f32_16x16x32_bf16 v[116:119], a[212:215], v[232:235], v[116:119]
    ds_read_b64_tr_b16 a[46:47], v11 offset:40960
    v_rcp_f32 v241, v241
    v_mfma_f32_16x16x32_bf16 v[120:123], a[200:203], v[184:187], v[120:123]
    buffer_load_dwordx4 v251, s[32:35], s66 offen offset:1024 lds
    v_rcp_f32 v242, v242
    v_mfma_f32_16x16x32_bf16 v[120:123], a[216:219], v[232:235], v[120:123]
    s_add_u32 m0, s69, 49152
    v_rcp_f32 v243, v243
    v_mfma_f32_16x16x32_bf16 v[124:127], a[204:207], v[184:187], v[124:127]
    s_mov_b32 s66, 286720
    v_rcp_f32 v244, v244
    v_mfma_f32_16x16x32_bf16 v[124:127], a[220:223], v[232:235], v[124:127]
    buffer_load_dwordx4 v2, s[32:35], s66 offen lds
    v_rcp_f32 v245, v245
    v_rcp_f32 v246, v246
    v_rcp_f32 v247, v247
    v_pk_mul_f32 v[48:49], v[48:49], v[240:241]
    v_pk_mul_f32 v[50:51], v[50:51], v[242:243]
    v_pk_mul_f32 v[52:53], v[52:53], v[244:245]
    v_pk_mul_f32 v[54:55], v[54:55], v[246:247]
    v_cvt_pk_bf16_f32 v56, v48, v49
    v_cvt_pk_bf16_f32 v57, v50, v51
    v_cvt_pk_bf16_f32 v58, v52, v53
    v_cvt_pk_bf16_f32 v59, v54, v55
L_tile3:
    v_pk_mul_f32 v[240:241], v[112:113], v[112:113]
    v_pk_mul_f32 v[242:243], v[114:115], v[114:115]
    v_pk_mul_f32 v[244:245], v[116:117], v[116:117]
    buffer_load_dwordx4 v251, s[32:35], s66 offen offset:1024 lds
    v_pk_mul_f32 v[246:247], v[118:119], v[118:119]
    v_pk_fma_f32 v[240:241], v[240:241], v[248:249], s[18:19]
    v_pk_fma_f32 v[242:243], v[242:243], v[248:249], s[18:19]
    s_mov_b32 s66, 307200
    v_pk_fma_f32 v[244:245], v[244:245], v[248:249], s[18:19]
    v_pk_fma_f32 v[246:247], v[246:247], v[248:249], s[18:19]
    s_add_u32 m0, s69, 57344
    v_pk_mul_f32 v[240:241], v[240:241], v[112:113]
    v_pk_mul_f32 v[242:243], v[242:243], v[114:115]
    v_pk_mul_f32 v[244:245], v[244:245], v[116:117]
    v_pk_mul_f32 v[246:247], v[246:247], v[118:119]
    s_waitcnt lgkmcnt(0)
    v_pk_mul_f32 v[112:113], v[112:113], v[120:121]
    v_pk_mul_f32 v[114:115], v[114:115], v[122:123]
    v_pk_mul_f32 v[116:117], v[116:117], v[124:125]
    v_pk_mul_f32 v[118:119], v[118:119], v[126:127]
    v_mfma_f32_16x16x32_bf16 v[72:75], v[152:155], v[172:175], v[72:75]
    s_add_u32 s67, s61, 110592
    buffer_store_dwordx4 v[56:59], v13, s[28:31], s67 offen sc1
    v_exp_f32 v240, v240
    v_mfma_f32_16x16x32_bf16 v[72:75], v[200:203], v[220:223], v[72:75]
    s_waitcnt vmcnt(19)
    ds_read_b64_tr_b16 a[48:49], v1 offset:49152
    v_exp_f32 v241, v241
    v_mfma_f32_16x16x32_bf16 v[76:79], v[156:159], v[172:175], v[76:79]
    ds_read_b64_tr_b16 a[52:53], v4 offset:49152
    v_exp_f32 v242, v242
    v_mfma_f32_16x16x32_bf16 v[76:79], v[204:207], v[220:223], v[76:79]
    ds_read_b64_tr_b16 a[56:57], v6 offset:49152
    v_exp_f32 v243, v243
    v_mfma_f32_16x16x32_bf16 v[32:35], a[192:195], v[164:167], v[32:35]
    ds_read_b128 v[172:175], v252 offset:6144
    v_exp_f32 v244, v244
    v_mfma_f32_16x16x32_bf16 v[32:35], a[208:211], v[212:215], v[32:35]
    buffer_load_dwordx4 v2, s[32:35], s66 offen lds
    v_exp_f32 v245, v245
    v_exp_f32 v246, v246
    v_exp_f32 v247, v247
    v_pk_add_f32 v[240:241], v[240:241], 1.0 op_sel_hi:[1,0]
    v_pk_add_f32 v[242:243], v[242:243], 1.0 op_sel_hi:[1,0]
    v_pk_add_f32 v[244:245], v[244:245], 1.0 op_sel_hi:[1,0]
    v_pk_add_f32 v[246:247], v[246:247], 1.0 op_sel_hi:[1,0]
    v_mfma_f32_16x16x32_bf16 v[36:39], a[196:199], v[164:167], v[36:39]
    ds_read_b128 v[220:223], v253 offset:6144
    v_rcp_f32 v240, v240
    v_mfma_f32_16x16x32_bf16 v[36:39], a[212:215], v[212:215], v[36:39]
    ds_read_b64_tr_b16 a[60:61], v250 offset:49152
    v_rcp_f32 v241, v241
    v_mfma_f32_16x16x32_bf16 v[40:43], a[200:203], v[164:167], v[40:43]
    buffer_load_dwordx4 v251, s[32:35], s66 offen offset:1024 lds
    v_rcp_f32 v242, v242
    v_mfma_f32_16x16x32_bf16 v[40:43], a[216:219], v[212:215], v[40:43]
    s_add_u32 m0, s69, 65536
    v_rcp_f32 v243, v243
    v_mfma_f32_16x16x32_bf16 v[44:47], a[204:207], v[164:167], v[44:47]
    s_mov_b32 s66, 327680
    v_rcp_f32 v244, v244
    v_mfma_f32_16x16x32_bf16 v[44:47], a[220:223], v[212:215], v[44:47]
    buffer_load_dwordx4 v2, s[32:35], s66 offen lds
    v_rcp_f32 v245, v245
    v_rcp_f32 v246, v246
    v_rcp_f32 v247, v247
    v_pk_mul_f32 v[112:113], v[112:113], v[240:241]
    v_pk_mul_f32 v[114:115], v[114:115], v[242:243]
    v_pk_mul_f32 v[116:117], v[116:117], v[244:245]
    v_pk_mul_f32 v[118:119], v[118:119], v[246:247]
    v_cvt_pk_bf16_f32 v120, v112, v113
    v_cvt_pk_bf16_f32 v121, v114, v115
    v_cvt_pk_bf16_f32 v122, v116, v117
    v_cvt_pk_bf16_f32 v123, v118, v119
L_tile4:
    s_branch L_pgt4
    .p2align 12
L_itt4:
    s_branch L_itbt4
L_pgt4:
    v_pk_mul_f32 v[240:241], v[32:33], v[32:33]
    v_pk_mul_f32 v[242:243], v[34:35], v[34:35]
    v_pk_mul_f32 v[244:245], v[36:37], v[36:37]
    buffer_load_dwordx4 v251, s[32:35], s66 offen offset:1024 lds
    v_pk_mul_f32 v[246:247], v[38:39], v[38:39]
    v_pk_fma_f32 v[240:241], v[240:241], v[248:249], s[18:19]
    v_pk_fma_f32 v[242:243], v[242:243], v[248:249], s[18:19]
    s_mov_b32 s66, 348160
    v_pk_fma_f32 v[244:245], v[244:245], v[248:249], s[18:19]
    v_pk_fma_f32 v[246:247], v[246:247], v[248:249], s[18:19]
    s_add_u32 m0, s69, 73728
    v_pk_mul_f32 v[240:241], v[240:241], v[32:33]
    v_pk_mul_f32 v[242:243], v[242:243], v[34:35]
    v_pk_mul_f32 v[244:245], v[244:245], v[36:37]
    v_pk_mul_f32 v[246:247], v[246:247], v[38:39]
    s_waitcnt lgkmcnt(0)
    v_pk_mul_f32 v[32:33], v[32:33], v[40:41]
    v_pk_mul_f32 v[34:35], v[34:35], v[42:43]
    v_pk_mul_f32 v[36:37], v[36:37], v[44:45]
    v_pk_mul_f32 v[38:39], v[38:39], v[46:47]
    v_mfma_f32_16x16x32_bf16 v[128:131], v[144:147], v[188:191], v[128:131]
    s_add_u32 s67, s61, 331776
    buffer_store_dwordx4 v[120:123], v13, s[28:31], s67 offen sc1
    v_exp_f32 v240, v240
    v_mfma_f32_16x16x32_bf16 v[128:131], v[192:195], v[236:239], v[128:131]
    s_waitcnt vmcnt(22)
    ds_read_b64_tr_b16 a[50:51], v1 offset:0
    v_exp_f32 v241, v241
    v_mfma_f32_16x16x32_bf16 v[132:135], v[148:151], v[188:191], v[132:135]
    s_waitcnt vmcnt(10)
    buffer_store_dword v7, v8, s[44:47], 0 offen sc1
    v_exp_f32 v242, v242
    v_mfma_f32_16x16x32_bf16 v[132:135], v[196:199], v[236:239], v[132:135]
    ds_read_b64_tr_b16 a[54:55], v4 offset:0
    v_exp_f32 v243, v243
    v_mfma_f32_16x16x32_bf16 v[96:99], a[192:195], v[180:183], v[96:99]
    ds_read_b64_tr_b16 a[58:59], v6 offset:0
    v_exp_f32 v244, v244
    v_mfma_f32_16x16x32_bf16 v[96:99], a[208:211], v[228:231], v[96:99]
    buffer_load_dwordx4 v2, s[32:35], s66 offen lds
    v_exp_f32 v245, v245
    v_exp_f32 v246, v246
    v_exp_f32 v247, v247
    v_pk_add_f32 v[240:241], v[240:241], 1.0 op_sel_hi:[1,0]
    v_pk_add_f32 v[242:243], v[242:243], 1.0 op_sel_hi:[1,0]
    v_pk_add_f32 v[244:245], v[244:245], 1.0 op_sel_hi:[1,0]
    v_pk_add_f32 v[246:247], v[246:247], 1.0 op_sel_hi:[1,0]
    v_mfma_f32_16x16x32_bf16 v[100:103], a[196:199], v[180:183], v[100:103]
    ds_read_b64_tr_b16 a[62:63], v250 offset:0
    v_rcp_f32 v240, v240
    v_mfma_f32_16x16x32_bf16 v[100:103], a[212:215], v[228:231], v[100:103]
    v_rcp_f32 v241, v241
    v_mfma_f32_16x16x32_bf16 v[104:107], a[200:203], v[180:183], v[104:107]
    buffer_load_dwordx4 v251, s[32:35], s66 offen offset:1024 lds
    v_rcp_f32 v242, v242
    v_mfma_f32_16x16x32_bf16 v[104:107], a[216:219], v[228:231], v[104:107]
    s_add_u32 m0, s69, 81920
    v_rcp_f32 v243, v243
    v_mfma_f32_16x16x32_bf16 v[108:111], a[204:207], v[180:183], v[108:111]
    s_mov_b32 s66, 368640
    v_rcp_f32 v244, v244
    v_mfma_f32_16x16x32_bf16 v[108:111], a[220:223], v[228:231], v[108:111]
    buffer_load_dwordx4 v2, s[32:35], s66 offen lds
    v_rcp_f32 v245, v245
    v_rcp_f32 v246, v246
    v_rcp_f32 v247, v247
    v_pk_mul_f32 v[32:33], v[32:33], v[240:241]
    v_pk_mul_f32 v[34:35], v[34:35], v[242:243]
    v_pk_mul_f32 v[36:37], v[36:37], v[244:245]
    v_pk_mul_f32 v[38:39], v[38:39], v[246:247]
    v_cvt_pk_bf16_f32 v40, v32, v33
    v_cvt_pk_bf16_f32 v41, v34, v35
    v_cvt_pk_bf16_f32 v42, v36, v37
    v_cvt_pk_bf16_f32 v43, v38, v39
    s_cmp_lg_u32 s74, 0
    s_cbranch_scc1 L_nogo
    s_lshl_b32 s58, s62, 10
    s_add_u32 s58, s58, 32768
    v_lshrrev_b32 v12, 3, v0
    v_lshl_add_u32 v12, v12, 13, v0
    v_lshl_add_u32 v12, v12, 7, s58
    buffer_store_dword v7, v12, s[44:47], 0 offen sc1
L_nogo:
L_tile5:
    v_pk_mul_f32 v[240:241], v[96:97], v[96:97]
    v_pk_mul_f32 v[242:243], v[98:99], v[98:99]
    v_pk_mul_f32 v[244:245], v[100:101], v[100:101]
    buffer_load_dwordx4 v251, s[32:35], s66 offen offset:1024 lds
    v_pk_mul_f32 v[246:247], v[102:103], v[102:103]
    v_pk_fma_f32 v[240:241], v[240:241], v[248:249], s[18:19]
    v_pk_fma_f32 v[242:243], v[242:243], v[248:249], s[18:19]
    s_mov_b32 s66, 389120
    v_pk_fma_f32 v[244:245], v[244:245], v[248:249], s[18:19]
    v_pk_fma_f32 v[246:247], v[246:247], v[248:249], s[18:19]
    s_add_u32 m0, s69, 90112
    v_pk_mul_f32 v[240:241], v[240:241], v[96:97]
    v_pk_mul_f32 v[242:243], v[242:243], v[98:99]
    v_pk_mul_f32 v[244:245], v[244:245], v[100:101]
    v_pk_mul_f32 v[246:247], v[246:247], v[102:103]
    s_waitcnt lgkmcnt(0)
    v_pk_mul_f32 v[96:97], v[96:97], v[104:105]
    v_pk_mul_f32 v[98:99], v[98:99], v[106:107]
    v_pk_mul_f32 v[100:101], v[100:101], v[108:109]
    v_pk_mul_f32 v[102:103], v[102:103], v[110:111]
    v_mfma_f32_16x16x32_bf16 v[136:139], v[152:155], v[188:191], v[136:139]
    s_add_u32 s67, s61, 55296
    buffer_store_dwordx4 v[40:43], v13, s[28:31], s67 offen sc1
    v_exp_f32 v240, v240
    v_mfma_f32_16x16x32_bf16 v[136:139], v[200:203], v[236:239], v[136:139]
    s_waitcnt vmcnt(26)
    ds_read_b64_tr_b16 a[64:65], v1 offset:8192
    v_exp_f32 v241, v241
    v_mfma_f32_16x16x32_bf16 v[140:143], v[156:159], v[188:191], v[140:143]
    ds_read_b64_tr_b16 a[68:69], v4 offset:8192
    v_exp_f32 v242, v242
    v_mfma_f32_16x16x32_bf16 v[140:143], v[204:207], v[236:239], v[140:143]
    ds_read_b64_tr_b16 a[72:73], v6 offset:8192
    v_exp_f32 v243, v243
    v_mfma_f32_16x16x32_bf16 v[64:67], a[192:195], v[172:175], v[64:67]
    ds_read_b128 v[188:191], v252 offset:14336
    v_exp_f32 v244, v244
    v_mfma_f32_16x16x32_bf16 v[64:67], a[208:211], v[220:223], v[64:67]
    buffer_load_dwordx4 v2, s[32:35], s66 offen lds
    v_exp_f32 v245, v245
    v_exp_f32 v246, v246
    v_exp_f32 v247, v247
    v_pk_add_f32 v[240:241], v[240:241], 1.0 op_sel_hi:[1,0]
    v_pk_add_f32 v[242:243], v[242:243], 1.0 op_sel_hi:[1,0]
    v_pk_add_f32 v[244:245], v[244:245], 1.0 op_sel_hi:[1,0]
    v_pk_add_f32 v[246:247], v[246:247], 1.0 op_sel_hi:[1,0]
    v_mfma_f32_16x16x32_bf16 v[68:71], a[196:199], v[172:175], v[68:71]
    ds_read_b128 v[236:239], v253 offset:14336
    v_rcp_f32 v240, v240
    v_mfma_f32_16x16x32_bf16 v[68:71], a[212:215], v[220:223], v[68:71]
    ds_read_b64_tr_b16 a[76:77], v250 offset:8192
    v_rcp_f32 v241, v241
    v_mfma_f32_16x16x32_bf16 v[72:75], a[200:203], v[172:175], v[72:75]
    buffer_load_dwordx4 v251, s[32:35], s66 offen offset:1024 lds
    v_rcp_f32 v242, v242
    v_mfma_f32_16x16x32_bf16 v[72:75], a[216:219], v[220:223], v[72:75]
    s_add_u32 m0, s69, 147456
    v_rcp_f32 v243, v243
    v_mfma_f32_16x16x32_bf16 v[76:79], a[204:207], v[172:175], v[76:79]
    s_mov_b32 s66, 409600
    v_rcp_f32 v244, v244
    v_mfma_f32_16x16x32_bf16 v[76:79], a[220:223], v[220:223], v[76:79]
    buffer_load_dwordx4 v2, s[32:35], s66 offen lds
    v_rcp_f32 v245, v245
    v_rcp_f32 v246, v246
    v_rcp_f32 v247, v247
    v_pk_mul_f32 v[96:97], v[96:97], v[240:241]
    v_pk_mul_f32 v[98:99], v[98:99], v[242:243]
    v_pk_mul_f32 v[100:101], v[100:101], v[244:245]
    v_pk_mul_f32 v[102:103], v[102:103], v[246:247]
    v_cvt_pk_bf16_f32 v104, v96, v97
    v_cvt_pk_bf16_f32 v105, v98, v99
    v_cvt_pk_bf16_f32 v106, v100, v101
    v_cvt_pk_bf16_f32 v107, v102, v103
L_tile6:
    v_pk_mul_f32 v[240:241], v[64:65], v[64:65]
    v_pk_mul_f32 v[242:243], v[66:67], v[66:67]
    v_pk_mul_f32 v[244:245], v[68:69], v[68:69]
    buffer_load_dwordx4 v251, s[32:35], s66 offen offset:1024 lds
    v_pk_mul_f32 v[246:247], v[70:71], v[70:71]
    v_pk_fma_f32 v[240:241], v[240:241], v[248:249], s[18:19]
    v_pk_fma_f32 v[242:243], v[242:243], v[248:249], s[18:19]
    s_mov_b32 s66, 430080
    v_pk_fma_f32 v[244:245], v[244:245], v[248:249], s[18:19]
    v_pk_fma_f32 v[246:247], v[246:247], v[248:249], s[18:19]
    s_add_u32 m0, s69, 98304
    v_pk_mul_f32 v[240:241], v[240:241], v[64:65]
    v_pk_mul_f32 v[242:243], v[242:243], v[66:67]
    v_pk_mul_f32 v[244:245], v[244:245], v[68:69]
    v_pk_mul_f32 v[246:247], v[246:247], v[70:71]
    s_waitcnt lgkmcnt(0)
    v_pk_mul_f32 v[64:65], v[64:65], v[72:73]
    v_pk_mul_f32 v[66:67], v[66:67], v[74:75]
    v_pk_mul_f32 v[68:69], v[68:69], v[76:77]
    v_pk_mul_f32 v[70:71], v[70:71], v[78:79]
    v_mfma_f32_16x16x32_bf16 v[128:131], a[192:195], v[188:191], v[128:131]
    s_add_u32 s67, s61, 276480
    buffer_store_dwordx4 v[104:107], v13, s[28:31], s67 offen sc1
    v_exp_f32 v240, v240
    v_mfma_f32_16x16x32_bf16 v[128:131], a[208:211], v[236:239], v[128:131]
    v_exp_f32 v241, v241
    v_mfma_f32_16x16x32_bf16 v[132:135], a[196:199], v[188:191], v[132:135]
    s_waitcnt vmcnt(11)
    buffer_store_dword v7, v8, s[44:47], s81 offen sc1
    v_exp_f32 v242, v242
    v_mfma_f32_16x16x32_bf16 v[132:135], a[212:215], v[236:239], v[132:135]
    v_exp_f32 v243, v243
    v_mfma_f32_16x16x32_bf16 v[136:139], a[200:203], v[188:191], v[136:139]
    v_exp_f32 v244, v244
    v_mfma_f32_16x16x32_bf16 v[136:139], a[216:219], v[236:239], v[136:139]
    buffer_load_dwordx4 v2, s[32:35], s66 offen lds
    v_exp_f32 v245, v245
    v_exp_f32 v246, v246
    v_exp_f32 v247, v247
    v_pk_add_f32 v[240:241], v[240:241], 1.0 op_sel_hi:[1,0]
    v_pk_add_f32 v[242:243], v[242:243], 1.0 op_sel_hi:[1,0]
    v_pk_add_f32 v[244:245], v[244:245], 1.0 op_sel_hi:[1,0]
    v_pk_add_f32 v[246:247], v[246:247], 1.0 op_sel_hi:[1,0]
    v_mfma_f32_16x16x32_bf16 v[140:143], a[204:207], v[188:191], v[140:143]
    v_rcp_f32 v240, v240
    v_mfma_f32_16x16x32_bf16 v[140:143], a[220:223], v[236:239], v[140:143]
    v_rcp_f32 v241, v241
    buffer_load_dwordx4 v251, s[32:35], s66 offen offset:1024 lds
    v_rcp_f32 v242, v242
    s_add_u32 m0, s69, 106496
    v_rcp_f32 v243, v243
    s_mov_b32 s66, 450560
    v_rcp_f32 v244, v244
    buffer_load_dwordx4 v2, s[32:35], s66 offen lds
    v_rcp_f32 v245, v245
    v_rcp_f32 v246, v246
    v_rcp_f32 v247, v247
    v_pk_mul_f32 v[64:65], v[64:65], v[240:241]
    v_pk_mul_f32 v[66:67], v[66:67], v[242:243]
    v_pk_mul_f32 v[68:69], v[68:69], v[244:245]
    v_pk_mul_f32 v[70:71], v[70:71], v[246:247]
    v_cvt_pk_bf16_f32 v72, v64, v65
    v_cvt_pk_bf16_f32 v73, v66, v67
    v_cvt_pk_bf16_f32 v74, v68, v69
    v_cvt_pk_bf16_f32 v75, v70, v71
L_tile7:
    v_pk_mul_f32 v[240:241], v[128:129], v[128:129]
    v_pk_mul_f32 v[242:243], v[130:131], v[130:131]
    v_pk_mul_f32 v[244:245], v[132:133], v[132:133]
    buffer_load_dwordx4 v251, s[32:35], s66 offen offset:1024 lds
    v_pk_mul_f32 v[246:247], v[134:135], v[134:135]
    v_pk_fma_f32 v[240:241], v[240:241], v[248:249], s[18:19]
    v_pk_fma_f32 v[242:243], v[242:243], v[248:249], s[18:19]
    v_pk_fma_f32 v[244:245], v[244:245], v[248:249], s[18:19]
    v_pk_fma_f32 v[246:247], v[246:247], v[248:249], s[18:19]
    v_pk_mul_f32 v[240:241], v[240:241], v[128:129]
    v_pk_mul_f32 v[242:243], v[242:243], v[130:131]
    v_pk_mul_f32 v[244:245], v[244:245], v[132:133]
    v_pk_mul_f32 v[246:247], v[246:247], v[134:135]
    v_pk_mul_f32 v[128:129], v[128:129], v[136:137]
    v_pk_mul_f32 v[130:131], v[130:131], v[138:139]
    v_pk_mul_f32 v[132:133], v[132:133], v[140:141]
    v_pk_mul_f32 v[134:135], v[134:135], v[142:143]
    s_add_u32 s67, s61, 165888
    buffer_store_dwordx4 v[72:75], v13, s[28:31], s67 offen sc1
    v_exp_f32 v240, v240
    v_exp_f32 v241, v241
    buffer_load_dword v14, v5, s[44:47], s4 offen sc1
    v_exp_f32 v242, v242
    v_exp_f32 v243, v243
    v_exp_f32 v244, v244
    v_exp_f32 v245, v245
    v_exp_f32 v246, v246
    v_exp_f32 v247, v247
    v_pk_add_f32 v[240:241], v[240:241], 1.0 op_sel_hi:[1,0]
    v_pk_add_f32 v[242:243], v[242:243], 1.0 op_sel_hi:[1,0]
    v_pk_add_f32 v[244:245], v[244:245], 1.0 op_sel_hi:[1,0]
    v_pk_add_f32 v[246:247], v[246:247], 1.0 op_sel_hi:[1,0]
    v_rcp_f32 v240, v240
    v_rcp_f32 v241, v241
    v_rcp_f32 v242, v242
    v_rcp_f32 v243, v243
    v_rcp_f32 v244, v244
    v_rcp_f32 v245, v245
    v_rcp_f32 v246, v246
    v_rcp_f32 v247, v247
    v_pk_mul_f32 v[128:129], v[128:129], v[240:241]
    v_pk_mul_f32 v[130:131], v[130:131], v[242:243]
    v_pk_mul_f32 v[132:133], v[132:133], v[244:245]
    v_pk_mul_f32 v[134:135], v[134:135], v[246:247]
    v_cvt_pk_bf16_f32 v136, v128, v129
    v_cvt_pk_bf16_f32 v137, v130, v131
    v_cvt_pk_bf16_f32 v138, v132, v133
    v_cvt_pk_bf16_f32 v139, v134, v135
    s_add_u32 s67, s61, 387072
    buffer_store_dwordx4 v[136:139], v13, s[28:31], s67 offen sc1
    s_waitcnt vmcnt(8)
    buffer_store_dword v7, v8, s[44:47], s3 offen sc1
L_post:
    s_waitcnt vmcnt(28)
    ds_read_b64_tr_b16 a[66:67], v1 offset:16384
    ds_read_b64_tr_b16 a[70:71], v4 offset:16384
    ds_read_b64_tr_b16 a[74:75], v6 offset:16384
    ds_read_b64_tr_b16 a[78:79], v250 offset:16384
    ds_read_b64_tr_b16 a[80:81], v1 offset:24576
    ds_read_b64_tr_b16 a[84:85], v4 offset:24576
    ds_read_b64_tr_b16 a[88:89], v6 offset:24576
    ds_read_b64_tr_b16 a[92:93], v250 offset:24576
    ds_read_b64_tr_b16 a[82:83], v1 offset:32768
    ds_read_b64_tr_b16 a[86:87], v4 offset:32768
    ds_read_b64_tr_b16 a[90:91], v6 offset:32768
    ds_read_b64_tr_b16 a[94:95], v250 offset:32768
    s_waitcnt lgkmcnt(8)
    s_add_u32 m0, s69, 114688
    s_mov_b32 s66, 471040
    buffer_load_dwordx4 v2, s[32:35], s66 offen lds
    buffer_load_dwordx4 v251, s[32:35], s66 offen offset:1024 lds
    ds_read_b64_tr_b16 a[96:97], v1 offset:40960
    ds_read_b64_tr_b16 a[100:101], v4 offset:40960
    ds_read_b64_tr_b16 a[104:105], v6 offset:40960
    ds_read_b64_tr_b16 a[108:109], v250 offset:40960
    s_waitcnt lgkmcnt(8)
    s_add_u32 m0, s69, 122880
    s_mov_b32 s66, 491520
    buffer_load_dwordx4 v2, s[32:35], s66 offen lds
    buffer_load_dwordx4 v251, s[32:35], s66 offen offset:1024 lds
    ds_read_b64_tr_b16 a[98:99], v1 offset:57344
    ds_read_b64_tr_b16 a[102:103], v4 offset:57344
    ds_read_b64_tr_b16 a[106:107], v6 offset:57344
    ds_read_b64_tr_b16 a[110:111], v250 offset:57344
    s_waitcnt lgkmcnt(8)
    s_waitcnt lgkmcnt(4)
    s_waitcnt lgkmcnt(0)
    v_accvgpr_read_b32 v208, a224
    v_accvgpr_read_b32 v209, a225
    v_accvgpr_read_b32 v210, a226
    v_accvgpr_read_b32 v211, a227
    v_accvgpr_read_b32 v212, a228
    s_waitcnt vmcnt(6)
    v_cmp_eq_u32 vcc, 1, v14
    s_cmp_lg_u64 vcc, s[10:11]
    s_cbranch_scc1 L_waitc0
L_goc0:
    s_add_u32 s67, s83, 0
    buffer_load_dwordx4 v[144:147], v211, s[28:31], s67 offen offset:0 sc1
    buffer_load_dwordx4 v[148:151], v211, s[28:31], s67 offen offset:1024 sc1
    buffer_load_dwordx4 v[152:155], v211, s[28:31], s67 offen offset:2048 sc1
    buffer_load_dwordx4 v[156:159], v211, s[28:31], s67 offen offset:3072 sc1
    buffer_load_dword v14, v5, s[44:47], s5 offen sc1
    s_add_u32 s67, s83, 4096
    buffer_load_dwordx4 v[160:163], v211, s[28:31], s67 offen offset:0 sc1
    buffer_load_dwordx4 v[164:167], v211, s[28:31], s67 offen offset:1024 sc1
    buffer_load_dwordx4 v[168:171], v211, s[28:31], s67 offen offset:2048 sc1
    buffer_load_dwordx4 v[172:175], v211, s[28:31], s67 offen offset:3072 sc1
    s_add_u32 m0, s69, 131072
    s_mov_b32 s66, 512000
    buffer_load_dwordx4 v2, s[32:35], s66 offen lds
    buffer_load_dwordx4 v251, s[32:35], s66 offen offset:1024 lds
    s_add_u32 m0, s69, 139264
    s_mov_b32 s66, 532480
    buffer_load_dwordx4 v2, s[32:35], s66 offen lds
    buffer_load_dwordx4 v251, s[32:35], s66 offen offset:1024 lds
    s_add_u32 m0, s69, 155648
    s_mov_b32 s66, 552960
    buffer_load_dwordx4 v2, s[32:35], s66 offen lds
    buffer_load_dwordx4 v251, s[32:35], s66 offen offset:1024 lds
    s_waitcnt vmcnt(45)
    ds_read_b64_tr_b16 a[112:113], v3 offset:0
    ds_read_b64_tr_b16 a[116:117], v9 offset:0
    ds_read_b64_tr_b16 a[120:121], v10 offset:0
    ds_read_b64_tr_b16 a[124:125], v11 offset:0
    s_waitcnt vmcnt(42)
    ds_read_b64_tr_b16 a[114:115], v3 offset:8192
    ds_read_b64_tr_b16 a[118:119], v9 offset:8192
    ds_read_b64_tr_b16 a[122:123], v10 offset:8192
    ds_read_b64_tr_b16 a[126:127], v11 offset:8192
    s_waitcnt vmcnt(40)
    ds_read_b64_tr_b16 a[128:129], v3 offset:16384
    ds_read_b64_tr_b16 a[132:133], v9 offset:16384
    ds_read_b64_tr_b16 a[136:137], v10 offset:16384
    ds_read_b64_tr_b16 a[140:141], v11 offset:16384
    s_waitcnt vmcnt(36)
    ds_read_b64_tr_b16 a[130:131], v3 offset:24576
    ds_read_b64_tr_b16 a[134:135], v9 offset:24576
    ds_read_b64_tr_b16 a[138:139], v10 offset:24576
    ds_read_b64_tr_b16 a[142:143], v11 offset:24576
L_rowc0:
    s_waitcnt vmcnt(13) lgkmcnt(14)
    v_mfma_f32_16x16x32_bf16 v[16:19], a[0:3], v[144:147], 0
    s_add_u32 s67, s83, 8192
    v_mfma_f32_16x16x32_bf16 v[16:19], a[16:19], v[148:151], v[16:19]
    buffer_load_dwordx4 v[176:179], v211, s[28:31], s67 offen offset:0 sc1
    v_mfma_f32_16x16x32_bf16 v[20:23], a[4:7], v[144:147], 0
    s_waitcnt vmcnt(35)
    ds_read_b64_tr_b16 a[144:145], v3 offset:32768
    ds_read_b64_tr_b16 a[148:149], v9 offset:32768
    v_mfma_f32_16x16x32_bf16 v[20:23], a[20:23], v[148:151], v[20:23]
    buffer_load_dwordx4 v[180:183], v211, s[28:31], s67 offen offset:1024 sc1
    v_mfma_f32_16x16x32_bf16 v[24:27], a[8:11], v[144:147], 0
    ds_read_b64_tr_b16 a[152:153], v10 offset:32768
    ds_read_b64_tr_b16 a[156:157], v11 offset:32768
    v_mfma_f32_16x16x32_bf16 v[24:27], a[24:27], v[148:151], v[24:27]
    buffer_load_dwordx4 v[184:187], v211, s[28:31], s67 offen offset:2048 sc1
    v_mfma_f32_16x16x32_bf16 v[28:31], a[12:15], v[144:147], 0
    s_waitcnt vmcnt(34)
    ds_read_b64_tr_b16 a[146:147], v3 offset:40960
    ds_read_b64_tr_b16 a[150:151], v9 offset:40960
    v_mfma_f32_16x16x32_bf16 v[28:31], a[28:31], v[148:151], v[28:31]
    buffer_load_dwordx4 v[188:191], v211, s[28:31], s67 offen offset:3072 sc1
    s_waitcnt vmcnt(15) lgkmcnt(14)
    v_mfma_f32_16x16x32_bf16 v[16:19], a[32:35], v[152:155], v[16:19]
    s_add_u32 s67, s83, 12288
    v_mfma_f32_16x16x32_bf16 v[16:19], a[48:51], v[156:159], v[16:19]
    buffer_load_dwordx4 v[192:195], v212, s[28:31], s67 offen offset:0 sc1
    v_mfma_f32_16x16x32_bf16 v[20:23], a[36:39], v[152:155], v[20:23]
    ds_read_b64_tr_b16 a[154:155], v10 offset:40960
    ds_read_b64_tr_b16 a[158:159], v11 offset:40960
    v_mfma_f32_16x16x32_bf16 v[20:23], a[52:55], v[156:159], v[20:23]
    buffer_load_dwordx4 v[144:147], v212, s[28:31], s67 offen offset:1024 sc1
    s_waitcnt vmcnt(26)
    buffer_store_dword v7, v8, s[44:47], s75 offen sc1
    v_mfma_f32_16x16x32_bf16 v[24:27], a[40:43], v[152:155], v[24:27]
    s_waitcnt vmcnt(17)
    v_cmp_eq_u32 vcc, 1, v14
    v_mfma_f32_16x16x32_bf16 v[24:27], a[56:59], v[156:159], v[24:27]
    s_cmp_lg_u64 vcc, s[10:11]
    s_cbranch_scc1 L_waitc1
L_goc1:
    s_add_u32 s67, s84, 0
    buffer_load_dwordx4 v[148:151], v211, s[28:31], s67 offen offset:0 sc1
    v_mfma_f32_16x16x32_bf16 v[28:31], a[44:47], v[152:155], v[28:31]
    s_waitcnt vmcnt(37)
    ds_read_b64_tr_b16 a[160:161], v1 offset:49152
    ds_read_b64_tr_b16 a[164:165], v4 offset:49152
    v_mfma_f32_16x16x32_bf16 v[28:31], a[60:63], v[156:159], v[28:31]
    ds_read_b64_tr_b16 a[168:169], v6 offset:49152
    ds_read_b64_tr_b16 a[172:173], v250 offset:49152
    s_waitcnt vmcnt(16) lgkmcnt(14)
    v_mfma_f32_16x16x32_bf16 v[16:19], a[64:67], v[160:163], v[16:19]
    s_waitcnt vmcnt(33)
    ds_read_b64_tr_b16 a[162:163], v1 offset:0
    ds_read_b64_tr_b16 a[166:167], v4 offset:0
    v_mfma_f32_16x16x32_bf16 v[16:19], a[80:83], v[164:167], v[16:19]
    buffer_load_dwordx4 v[152:155], v211, s[28:31], s67 offen offset:1024 sc1
    v_mfma_f32_16x16x32_bf16 v[20:23], a[68:71], v[160:163], v[20:23]
    ds_read_b64_tr_b16 a[170:171], v6 offset:0
    ds_read_b64_tr_b16 a[174:175], v250 offset:0
    v_mfma_f32_16x16x32_bf16 v[20:23], a[84:87], v[164:167], v[20:23]
    s_waitcnt vmcnt(32)
    ds_read_b64_tr_b16 a[176:177], v1 offset:8192
    ds_read_b64_tr_b16 a[180:181], v4 offset:8192
    v_mfma_f32_16x16x32_bf16 v[24:27], a[72:75], v[160:163], v[24:27]
    ds_read_b64_tr_b16 a[184:185], v6 offset:8192
    ds_read_b64_tr_b16 a[188:189], v250 offset:8192
    v_mfma_f32_16x16x32_bf16 v[24:27], a[88:91], v[164:167], v[24:27]
    buffer_load_dwordx4 v[156:159], v211, s[28:31], s67 offen offset:2048 sc1
    v_mfma_f32_16x16x32_bf16 v[28:31], a[76:79], v[160:163], v[28:31]
    s_waitcnt vmcnt(27)
    ds_read_b64_tr_b16 a[178:179], v1 offset:16384
    ds_read_b64_tr_b16 a[182:183], v4 offset:16384
    v_mfma_f32_16x16x32_bf16 v[28:31], a[92:95], v[164:167], v[28:31]
    ds_read_b64_tr_b16 a[186:187], v6 offset:16384
    ds_read_b64_tr_b16 a[190:191], v250 offset:16384
    s_waitcnt vmcnt(16) lgkmcnt(14)
    v_mfma_f32_16x16x32_bf16 v[16:19], a[96:99], v[168:171], v[16:19]
    s_waitcnt vmcnt(25)
    ds_read_b64_tr_b16 a[192:193], v1 offset:24576
    ds_read_b64_tr_b16 a[196:197], v4 offset:24576
    v_mfma_f32_16x16x32_bf16 v[16:19], a[112:115], v[172:175], v[16:19]
    buffer_load_dwordx4 v[160:163], v211, s[28:31], s67 offen offset:3072 sc1
    v_mfma_f32_16x16x32_bf16 v[20:23], a[100:103], v[168:171], v[20:23]
    s_add_u32 s67, s84, 4096
    v_mfma_f32_16x16x32_bf16 v[20:23], a[116:119], v[172:175], v[20:23]
    buffer_load_dword v14, v5, s[44:47], s6 offen sc1
    v_mfma_f32_16x16x32_bf16 v[24:27], a[104:107], v[168:171], v[24:27]
    ds_read_b64_tr_b16 a[200:201], v6 offset:24576
    ds_read_b64_tr_b16 a[204:205], v250 offset:24576
    v_mfma_f32_16x16x32_bf16 v[24:27], a[120:123], v[172:175], v[24:27]
    buffer_load_dwordx4 v[164:167], v211, s[28:31], s67 offen offset:0 sc1
    v_mfma_f32_16x16x32_bf16 v[28:31], a[108:111], v[168:171], v[28:31]
    s_waitcnt vmcnt(17)
    ds_read_b64_tr_b16 a[194:195], v1 offset:32768
    ds_read_b64_tr_b16 a[198:199], v4 offset:32768
    v_mfma_f32_16x16x32_bf16 v[28:31], a[124:127], v[172:175], v[28:31]
    ds_read_b64_tr_b16 a[202:203], v6 offset:32768
    ds_read_b64_tr_b16 a[206:207], v250 offset:32768
    s_waitcnt vmcnt(11) lgkmcnt(14)
    v_mfma_f32_16x16x32_bf16 v[16:19], a[128:131], v[176:179], v[16:19]
    s_waitcnt vmcnt(15)
    ds_read_b64_tr_b16 a[208:209], v1 offset:40960
    ds_read_b64_tr_b16 a[212:213], v4 offset:40960
    v_mfma_f32_16x16x32_bf16 v[16:19], a[144:147], v[180:183], v[16:19]
    buffer_load_dwordx4 v[168:171], v211, s[28:31], s67 offen offset:1024 sc1
    v_mfma_f32_16x16x32_bf16 v[20:23], a[132:135], v[176:179], v[20:23]
    ds_read_b64_tr_b16 a[216:217], v6 offset:40960
    ds_read_b64_tr_b16 a[220:221], v250 offset:40960
    v_mfma_f32_16x16x32_bf16 v[20:23], a[148:151], v[180:183], v[20:23]
    s_waitcnt vmcnt(14)
    ds_read_b64_tr_b16 a[210:211], v1 offset:57344
    ds_read_b64_tr_b16 a[214:215], v4 offset:57344
    v_mfma_f32_16x16x32_bf16 v[24:27], a[136:139], v[176:179], v[24:27]
    ds_read_b64_tr_b16 a[218:219], v6 offset:57344
    ds_read_b64_tr_b16 a[222:223], v250 offset:57344
    v_mfma_f32_16x16x32_bf16 v[24:27], a[152:155], v[180:183], v[24:27]
    buffer_load_dwordx4 v[172:175], v211, s[28:31], s67 offen offset:2048 sc1
    v_mfma_f32_16x16x32_bf16 v[28:31], a[140:143], v[176:179], v[28:31]
    v_mfma_f32_16x16x32_bf16 v[28:31], a[156:159], v[180:183], v[28:31]
    s_waitcnt vmcnt(11) lgkmcnt(14)
    v_mfma_f32_16x16x32_bf16 v[16:19], a[160:163], v[184:187], v[16:19]
    v_mfma_f32_16x16x32_bf16 v[16:19], a[176:179], v[188:191], v[16:19]
    buffer_load_dwordx4 v[176:179], v211, s[28:31], s67 offen offset:3072 sc1
    v_mfma_f32_16x16x32_bf16 v[20:23], a[164:167], v[184:187], v[20:23]
    s_add_u32 s67, s84, 8192
    v_mfma_f32_16x16x32_bf16 v[20:23], a[180:183], v[188:191], v[20:23]
    v_mfma_f32_16x16x32_bf16 v[24:27], a[168:171], v[184:187], v[24:27]
    v_mfma_f32_16x16x32_bf16 v[24:27], a[184:187], v[188:191], v[24:27]
    buffer_load_dwordx4 v[180:183], v211, s[28:31], s67 offen offset:0 sc1
    v_mfma_f32_16x16x32_bf16 v[28:31], a[172:175], v[184:187], v[28:31]
    v_mfma_f32_16x16x32_bf16 v[28:31], a[188:191], v[188:191], v[28:31]
    s_waitcnt vmcnt(11) lgkmcnt(0)
    v_mfma_f32_16x16x32_bf16 v[16:19], a[192:195], v[192:195], v[16:19]
    v_mfma_f32_16x16x32_bf16 v[16:19], a[208:211], v[144:147], v[16:19]
    buffer_load_dwordx4 v[184:187], v211, s[28:31], s67 offen offset:1024 sc1
    v_mfma_f32_16x16x32_bf16 v[20:23], a[196:199], v[192:195], v[20:23]
    v_mfma_f32_16x16x32_bf16 v[20:23], a[212:215], v[144:147], v[20:23]
    v_mfma_f32_16x16x32_bf16 v[24:27], a[200:203], v[192:195], v[24:27]
    v_mfma_f32_16x16x32_bf16 v[24:27], a[216:219], v[144:147], v[24:27]
    buffer_load_dwordx4 v[188:191], v211, s[28:31], s67 offen offset:2048 sc1
    v_mfma_f32_16x16x32_bf16 v[28:31], a[204:207], v[192:195], v[28:31]
    v_mfma_f32_16x16x32_bf16 v[28:31], a[220:223], v[144:147], v[28:31]
L_rowc1:
    s_branch L_pgr1
L_waitc0:
    s_mov_b32 s68, 0
L_waitc0_l:
    buffer_load_dword v14, v5, s[44:47], s4 offen sc1
    s_waitcnt vmcnt(0)
    v_cmp_eq_u32 vcc, 1, v14
    s_bcnt1_i32_b64 s58, vcc
    s_cmp_eq_u32 s58, s72
    s_cbranch_scc1 L_goc0
    s_add_u32 s68, s68, 1
    s_cmp_gt_u32 s68, 200000
    s_cbranch_scc1 L_goc0
    s_sleep 2
    s_branch L_waitc0_l
L_waitc1:
    s_mov_b32 s68, 0
L_waitc1_l:
    buffer_load_dword v14, v5, s[44:47], s5 offen sc1
    s_waitcnt vmcnt(0)
    v_cmp_eq_u32 vcc, 1, v14
    s_bcnt1_i32_b64 s58, vcc
    s_cmp_eq_u32 s58, s72
    s_cbranch_scc1 L_goc1
    s_add_u32 s68, s68, 1
    s_cmp_gt_u32 s68, 200000
    s_cbranch_scc1 L_goc1
    s_sleep 2
    s_branch L_waitc1_l
L_waitc2:
    s_mov_b32 s68, 0
L_waitc2_l:
    buffer_load_dword v14, v5, s[44:47], s6 offen sc1
    s_waitcnt vmcnt(0)
    v_cmp_eq_u32 vcc, 1, v14
    s_bcnt1_i32_b64 s58, vcc
    s_cmp_eq_u32 s58, s72
    s_cbranch_scc1 L_goc2
    s_add_u32 s68, s68, 1
    s_cmp_gt_u32 s68, 200000
    s_cbranch_scc1 L_goc2
    s_sleep 2
    s_branch L_waitc2_l
L_waitc3:
    s_mov_b32 s68, 0
L_waitc3_l:
    buffer_load_dword v14, v5, s[44:47], s7 offen sc1
    s_waitcnt vmcnt(0)
    v_cmp_eq_u32 vcc, 1, v14
    s_bcnt1_i32_b64 s58, vcc
    s_cmp_eq_u32 s58, s72
    s_cbranch_scc1 L_goc3
    s_add_u32 s68, s68, 1
    s_cmp_gt_u32 s68, 200000
    s_cbranch_scc1 L_goc3
    s_sleep 2
    s_branch L_waitc3_l
L_waitc4:
    s_mov_b32 s68, 0
L_waitc4_l:
    buffer_load_dword v14, v5, s[44:47], s8 offen sc1
    s_waitcnt vmcnt(0)
    v_cmp_eq_u32 vcc, 1, v14
    s_bcnt1_i32_b64 s58, vcc
    s_cmp_eq_u32 s58, s72
    s_cbranch_scc1 L_goc4
    s_add_u32 s68, s68, 1
    s_cmp_gt_u32 s68, 200000
    s_cbranch_scc1 L_goc4
    s_sleep 2
    s_branch L_waitc4_l
    .p2align 12
L_itr1:
    s_branch L_itbr1
L_pgr1:
    s_waitcnt vmcnt(10)
    v_mfma_f32_16x16x32_bf16 v[32:35], a[0:3], v[148:151], 0
    v_mfma_f32_16x16x32_bf16 v[32:35], a[16:19], v[152:155], v[32:35]
    buffer_load_dwordx4 v[192:195], v211, s[28:31], s67 offen offset:3072 sc1
    v_mfma_f32_16x16x32_bf16 v[36:39], a[4:7], v[148:151], 0
    s_add_u32 s67, s84, 12288
    v_mfma_f32_16x16x32_bf16 v[36:39], a[20:23], v[152:155], v[36:39]
    v_mfma_f32_16x16x32_bf16 v[40:43], a[8:11], v[148:151], 0
    v_mfma_f32_16x16x32_bf16 v[40:43], a[24:27], v[152:155], v[40:43]
    buffer_load_dwordx4 v[144:147], v212, s[28:31], s67 offen offset:0 sc1
    v_mfma_f32_16x16x32_bf16 v[44:47], a[12:15], v[148:151], 0
    v_mfma_f32_16x16x32_bf16 v[44:47], a[28:31], v[152:155], v[44:47]
    s_barrier
    s_waitcnt vmcnt(10)
    v_mfma_f32_16x16x32_bf16 v[32:35], a[32:35], v[156:159], v[32:35]
    v_mfma_f32_16x16x32_bf16 v[32:35], a[48:51], v[160:163], v[32:35]
    buffer_load_dwordx4 v[148:151], v212, s[28:31], s67 offen offset:1024 sc1
    v_mfma_f32_16x16x32_bf16 v[36:39], a[36:39], v[156:159], v[36:39]
    ds_write_b128 v210, v[16:19] offset:0
    v_mfma_f32_16x16x32_bf16 v[36:39], a[52:55], v[160:163], v[36:39]
    s_waitcnt vmcnt(10)
    v_cmp_eq_u32 vcc, 1, v14
    v_mfma_f32_16x16x32_bf16 v[40:43], a[40:43], v[156:159], v[40:43]
    s_cmp_lg_u64 vcc, s[10:11]
    s_cbranch_scc1 L_waitc2
L_goc2:
    v_mfma_f32_16x16x32_bf16 v[40:43], a[56:59], v[160:163], v[40:43]
    s_add_u32 s67, s85, 0
    buffer_load_dwordx4 v[152:155], v211, s[28:31], s67 offen offset:0 sc1
    v_mfma_f32_16x16x32_bf16 v[44:47], a[44:47], v[156:159], v[44:47]
    ds_write_b128 v210, v[20:23] offset:1056
    v_mfma_f32_16x16x32_bf16 v[44:47], a[60:63], v[160:163], v[44:47]
    s_waitcnt vmcnt(9)
    v_mfma_f32_16x16x32_bf16 v[32:35], a[64:67], v[164:167], v[32:35]
    v_mfma_f32_16x16x32_bf16 v[32:35], a[80:83], v[168:171], v[32:35]
    buffer_load_dwordx4 v[156:159], v211, s[28:31], s67 offen offset:1024 sc1
    v_mfma_f32_16x16x32_bf16 v[36:39], a[68:71], v[164:167], v[36:39]
    ds_write_b128 v210, v[24:27] offset:2112
    v_mfma_f32_16x16x32_bf16 v[36:39], a[84:87], v[168:171], v[36:39]
    v_mfma_f32_16x16x32_bf16 v[40:43], a[72:75], v[164:167], v[40:43]
    v_mfma_f32_16x16x32_bf16 v[40:43], a[88:91], v[168:171], v[40:43]
    buffer_load_dwordx4 v[160:163], v211, s[28:31], s67 offen offset:2048 sc1
    v_mfma_f32_16x16x32_bf16 v[44:47], a[76:79], v[164:167], v[44:47]
    ds_write_b128 v210, v[28:31] offset:3168
    v_mfma_f32_16x16x32_bf16 v[44:47], a[92:95], v[168:171], v[44:47]
    s_waitcnt vmcnt(9)
    v_mfma_f32_16x16x32_bf16 v[32:35], a[96:99], v[172:175], v[32:35]
    v_mfma_f32_16x16x32_bf16 v[32:35], a[112:115], v[176:179], v[32:35]
    buffer_load_dwordx4 v[164:167], v211, s[28:31], s67 offen offset:3072 sc1
    v_mfma_f32_16x16x32_bf16 v[36:39], a[100:103], v[172:175], v[36:39]
    s_add_u32 s67, s85, 4096
    v_mfma_f32_16x16x32_bf16 v[36:39], a[116:119], v[176:179], v[36:39]
    buffer_load_dword v14, v5, s[44:47], s7 offen sc1
    v_mfma_f32_16x16x32_bf16 v[40:43], a[104:107], v[172:175], v[40:43]
    v_mfma_f32_16x16x32_bf16 v[40:43], a[120:123], v[176:179], v[40:43]
    buffer_load_dwordx4 v[168:171], v211, s[28:31], s67 offen offset:0 sc1
    v_mfma_f32_16x16x32_bf16 v[44:47], a[108:111], v[172:175], v[44:47]
    v_mfma_f32_16x16x32_bf16 v[44:47], a[124:127], v[176:179], v[44:47]
    s_waitcnt vmcnt(10)
    v_mfma_f32_16x16x32_bf16 v[32:35], a[128:131], v[180:183], v[32:35]
    v_mfma_f32_16x16x32_bf16 v[32:35], a[144:147], v[184:187], v[32:35]
    buffer_load_dwordx4 v[172:175], v211, s[28:31], s67 offen offset:1024 sc1
    v_mfma_f32_16x16x32_bf16 v[36:39], a[132:135], v[180:183], v[36:39]
    v_mfma_f32_16x16x32_bf16 v[36:39], a[148:151], v[184:187], v[36:39]
    v_mfma_f32_16x16x32_bf16 v[40:43], a[136:139], v[180:183], v[40:43]
    v_mfma_f32_16x16x32_bf16 v[40:43], a[152:155], v[184:187], v[40:43]
    buffer_load_dwordx4 v[176:179], v211, s[28:31], s67 offen offset:2048 sc1
    v_mfma_f32_16x16x32_bf16 v[44:47], a[140:143], v[180:183], v[44:47]
    v_mfma_f32_16x16x32_bf16 v[44:47], a[156:159], v[184:187], v[44:47]
    s_waitcnt vmcnt(10)
    v_mfma_f32_16x16x32_bf16 v[32:35], a[160:163], v[188:191], v[32:35]
    v_mfma_f32_16x16x32_bf16 v[32:35], a[176:179], v[192:195], v[32:35]
    buffer_load_dwordx4 v[180:183], v211, s[28:31], s67 offen offset:3072 sc1
    v_mfma_f32_16x16x32_bf16 v[36:39], a[164:167], v[188:191], v[36:39]
    s_add_u32 s67, s85, 8192
    v_mfma_f32_16x16x32_bf16 v[36:39], a[180:183], v[192:195], v[36:39]
    v_mfma_f32_16x16x32_bf16 v[40:43], a[168:171], v[188:191], v[40:43]
    v_mfma_f32_16x16x32_bf16 v[40:43], a[184:187], v[192:195], v[40:43]
    buffer_load_dwordx4 v[184:187], v211, s[28:31], s67 offen offset:0 sc1
    v_mfma_f32_16x16x32_bf16 v[44:47], a[172:175], v[188:191], v[44:47]
    v_mfma_f32_16x16x32_bf16 v[44:47], a[188:191], v[192:195], v[44:47]
    s_waitcnt vmcnt(10)
    v_mfma_f32_16x16x32_bf16 v[32:35], a[192:195], v[144:147], v[32:35]
    v_mfma_f32_16x16x32_bf16 v[32:35], a[208:211], v[148:151], v[32:35]
    buffer_load_dwordx4 v[188:191], v211, s[28:31], s67 offen offset:1024 sc1
    v_mfma_f32_16x16x32_bf16 v[36:39], a[196:199], v[144:147], v[36:39]
    v_mfma_f32_16x16x32_bf16 v[36:39], a[212:215], v[148:151], v[36:39]
    v_mfma_f32_16x16x32_bf16 v[40:43], a[200:203], v[144:147], v[40:43]
    v_mfma_f32_16x16x32_bf16 v[40:43], a[216:219], v[148:151], v[40:43]
    buffer_load_dwordx4 v[192:195], v211, s[28:31], s67 offen offset:2048 sc1
    v_mfma_f32_16x16x32_bf16 v[44:47], a[204:207], v[144:147], v[44:47]
    v_mfma_f32_16x16x32_bf16 v[44:47], a[220:223], v[148:151], v[44:47]
L_rowc2:
    s_waitcnt vmcnt(10)
    v_mfma_f32_16x16x32_bf16 v[96:99], a[0:3], v[152:155], 0
    v_mfma_f32_16x16x32_bf16 v[96:99], a[16:19], v[156:159], v[96:99]
    buffer_load_dwordx4 v[144:147], v211, s[28:31], s67 offen offset:3072 sc1
    v_mfma_f32_16x16x32_bf16 v[100:103], a[4:7], v[152:155], 0
    s_add_u32 s67, s85, 12288
    v_mfma_f32_16x16x32_bf16 v[100:103], a[20:23], v[156:159], v[100:103]
    v_mfma_f32_16x16x32_bf16 v[104:107], a[8:11], v[152:155], 0
    v_mfma_f32_16x16x32_bf16 v[104:107], a[24:27], v[156:159], v[104:107]
    buffer_load_dwordx4 v[148:151], v212, s[28:31], s67 offen offset:0 sc1
    v_mfma_f32_16x16x32_bf16 v[108:111], a[12:15], v[152:155], 0
    v_mfma_f32_16x16x32_bf16 v[108:111], a[28:31], v[156:159], v[108:111]
    s_waitcnt vmcnt(10)
    v_mfma_f32_16x16x32_bf16 v[96:99], a[32:35], v[160:163], v[96:99]
    v_mfma_f32_16x16x32_bf16 v[96:99], a[48:51], v[164:167], v[96:99]
    buffer_load_dwordx4 v[152:155], v212, s[28:31], s67 offen offset:1024 sc1
    v_mfma_f32_16x16x32_bf16 v[100:103], a[36:39], v[160:163], v[100:103]
    ds_write_b128 v210, v[32:35] offset:16896
    v_mfma_f32_16x16x32_bf16 v[100:103], a[52:55], v[164:167], v[100:103]
    s_waitcnt vmcnt(10)
    v_cmp_eq_u32 vcc, 1, v14
    v_mfma_f32_16x16x32_bf16 v[104:107], a[40:43], v[160:163], v[104:107]
    s_cmp_lg_u64 vcc, s[10:11]
    s_cbranch_scc1 L_waitc3
L_goc3:
    v_mfma_f32_16x16x32_bf16 v[104:107], a[56:59], v[164:167], v[104:107]
    s_add_u32 s67, s86, 0
    buffer_load_dwordx4 v[156:159], v211, s[28:31], s67 offen offset:0 sc1
    v_mfma_f32_16x16x32_bf16 v[108:111], a[44:47], v[160:163], v[108:111]
    ds_write_b128 v210, v[36:39] offset:17952
    v_mfma_f32_16x16x32_bf16 v[108:111], a[60:63], v[164:167], v[108:111]
    s_waitcnt vmcnt(9)
    v_mfma_f32_16x16x32_bf16 v[96:99], a[64:67], v[168:171], v[96:99]
    v_mfma_f32_16x16x32_bf16 v[96:99], a[80:83], v[172:175], v[96:99]
    buffer_load_dwordx4 v[160:163], v211, s[28:31], s67 offen offset:1024 sc1
    v_mfma_f32_16x16x32_bf16 v[100:103], a[68:71], v[168:171], v[100:103]
    ds_write_b128 v210, v[40:43] offset:19008
    v_mfma_f32_16x16x32_bf16 v[100:103], a[84:87], v[172:175], v[100:103]
    v_mfma_f32_16x16x32_bf16 v[104:107], a[72:75], v[168:171], v[104:107]
    v_mfma_f32_16x16x32_bf16 v[104:107], a[88:91], v[172:175], v[104:107]
    buffer_load_dwordx4 v[164:167], v211, s[28:31], s67 offen offset:2048 sc1
    v_mfma_f32_16x16x32_bf16 v[108:111], a[76:79], v[168:171], v[108:111]
    ds_write_b128 v210, v[44:47] offset:20064
    v_mfma_f32_16x16x32_bf16 v[108:111], a[92:95], v[172:175], v[108:111]
    s_waitcnt vmcnt(9)
    v_mfma_f32_16x16x32_bf16 v[96:99], a[96:99], v[176:179], v[96:99]
    v_mfma_f32_16x16x32_bf16 v[96:99], a[112:115], v[180:183], v[96:99]
    buffer_load_dwordx4 v[168:171], v211, s[28:31], s67 offen offset:3072 sc1
    v_mfma_f32_16x16x32_bf16 v[100:103], a[100:103], v[176:179], v[100:103]
    s_add_u32 s67, s86, 4096
    v_mfma_f32_16x16x32_bf16 v[100:103], a[116:119], v[180:183], v[100:103]
    s_waitcnt lgkmcnt(0)
    s_barrier
    v_mfma_f32_16x16x32_bf16 v[104:107], a[104:107], v[176:179], v[104:107]
    ds_read_b128 v[56:59], v209 offset:0
    v_mfma_f32_16x16x32_bf16 v[104:107], a[120:123], v[180:183], v[104:107]
    buffer_load_dwordx4 v[172:175], v211, s[28:31], s67 offen offset:0 sc1
    v_mfma_f32_16x16x32_bf16 v[108:111], a[108:111], v[176:179], v[108:111]
    ds_read_b128 v[60:63], v209 offset:256
    v_mfma_f32_16x16x32_bf16 v[108:111], a[124:127], v[180:183], v[108:111]
    buffer_load_dword v14, v5, s[44:47], s8 offen sc1
    s_waitcnt vmcnt(10)
    v_mfma_f32_16x16x32_bf16 v[96:99], a[128:131], v[184:187], v[96:99]
    ds_read_b128 v[64:67], v209 offset:4224
    v_mfma_f32_16x16x32_bf16 v[96:99], a[144:147], v[188:191], v[96:99]
    buffer_load_dwordx4 v[176:179], v211, s[28:31], s67 offen offset:1024 sc1
    v_mfma_f32_16x16x32_bf16 v[100:103], a[132:135], v[184:187], v[100:103]
    ds_read_b128 v[68:71], v209 offset:4480
    v_mfma_f32_16x16x32_bf16 v[100:103], a[148:151], v[188:191], v[100:103]
    ds_read_b128 v[72:75], v209 offset:8448
    v_mfma_f32_16x16x32_bf16 v[104:107], a[136:139], v[184:187], v[104:107]
    ds_read_b128 v[76:79], v209 offset:8704
    v_mfma_f32_16x16x32_bf16 v[104:107], a[152:155], v[188:191], v[104:107]
    buffer_load_dwordx4 v[180:183], v211, s[28:31], s67 offen offset:2048 sc1
    v_mfma_f32_16x16x32_bf16 v[108:111], a[140:143], v[184:187], v[108:111]
    ds_read_b128 v[80:83], v209 offset:12672
    v_mfma_f32_16x16x32_bf16 v[108:111], a[156:159], v[188:191], v[108:111]
    ds_read_b128 v[84:87], v209 offset:12928
    s_waitcnt vmcnt(10)
    v_mfma_f32_16x16x32_bf16 v[96:99], a[160:163], v[192:195], v[96:99]
    v_mfma_f32_16x16x32_bf16 v[96:99], a[176:179], v[144:147], v[96:99]
    buffer_load_dwordx4 v[184:187], v211, s[28:31], s67 offen offset:3072 sc1
    v_mfma_f32_16x16x32_bf16 v[100:103], a[164:167], v[192:195], v[100:103]
    s_add_u32 s67, s86, 8192
    v_mfma_f32_16x16x32_bf16 v[100:103], a[180:183], v[144:147], v[100:103]
    v_mfma_f32_16x16x32_bf16 v[104:107], a[168:171], v[192:195], v[104:107]
    s_waitcnt lgkmcnt(4)
    v_add_f32 v56, v56, v64
    v_add_f32 v57, v57, v65
    v_mfma_f32_16x16x32_bf16 v[104:107], a[184:187], v[144:147], v[104:107]
    buffer_load_dwordx4 v[188:191], v211, s[28:31], s67 offen offset:0 sc1
    v_mfma_f32_16x16x32_bf16 v[108:111], a[172:175], v[192:195], v[108:111]
    v_add_f32 v58, v58, v66
    v_add_f32 v59, v59, v67
    v_mfma_f32_16x16x32_bf16 v[108:111], a[188:191], v[144:147], v[108:111]
    v_add_f32 v60, v60, v68
    v_add_f32 v61, v61, v69
    s_waitcnt vmcnt(10)
    v_mfma_f32_16x16x32_bf16 v[96:99], a[192:195], v[148:151], v[96:99]
    v_add_f32 v62, v62, v70
    v_add_f32 v63, v63, v71
    v_mfma_f32_16x16x32_bf16 v[96:99], a[208:211], v[152:155], v[96:99]
    buffer_load_dwordx4 v[192:195], v211, s[28:31], s67 offen offset:1024 sc1
    v_mfma_f32_16x16x32_bf16 v[100:103], a[196:199], v[148:151], v[100:103]
    s_waitcnt lgkmcnt(2)
    v_add_f32 v56, v56, v72
    v_add_f32 v57, v57, v73
    v_mfma_f32_16x16x32_bf16 v[100:103], a[212:215], v[152:155], v[100:103]
    v_add_f32 v58, v58, v74
    v_add_f32 v59, v59, v75
    v_mfma_f32_16x16x32_bf16 v[104:107], a[200:203], v[148:151], v[104:107]
    v_add_f32 v60, v60, v76
    v_add_f32 v61, v61, v77
    v_mfma_f32_16x16x32_bf16 v[104:107], a[216:219], v[152:155], v[104:107]
    buffer_load_dwordx4 v[144:147], v211, s[28:31], s67 offen offset:2048 sc1
    v_mfma_f32_16x16x32_bf16 v[108:111], a[204:207], v[148:151], v[108:111]
    v_add_f32 v62, v62, v78
    v_add_f32 v63, v63, v79
    v_mfma_f32_16x16x32_bf16 v[108:111], a[220:223], v[152:155], v[108:111]
    s_waitcnt lgkmcnt(0)
    v_add_f32 v56, v56, v80
    v_add_f32 v57, v57, v81
L_rowc3:
    s_waitcnt vmcnt(10)
    v_mfma_f32_16x16x32_bf16 v[16:19], a[0:3], v[156:159], 0
    v_add_f32 v58, v58, v82
    v_add_f32 v59, v59, v83
    v_mfma_f32_16x16x32_bf16 v[16:19], a[16:19], v[160:163], v[16:19]
    buffer_load_dwordx4 v[148:151], v211, s[28:31], s67 offen offset:3072 sc1
    v_mfma_f32_16x16x32_bf16 v[20:23], a[4:7], v[156:159], 0
    s_add_u32 s67, s86, 12288
    v_mfma_f32_16x16x32_bf16 v[20:23], a[20:23], v[160:163], v[20:23]
    v_add_f32 v60, v60, v84
    v_add_f32 v61, v61, v85
    v_mfma_f32_16x16x32_bf16 v[24:27], a[8:11], v[156:159], 0
    v_add_f32 v62, v62, v86
    v_add_f32 v63, v63, v87
    v_mfma_f32_16x16x32_bf16 v[24:27], a[24:27], v[160:163], v[24:27]
    buffer_load_dwordx4 v[152:155], v212, s[28:31], s67 offen offset:0 sc1
    v_mfma_f32_16x16x32_bf16 v[28:31], a[12:15], v[156:159], 0
    v_cvt_pk_bf16_f32 v88, v56, v57
    v_cvt_pk_bf16_f32 v89, v58, v59
    v_mfma_f32_16x16x32_bf16 v[28:31], a[28:31], v[160:163], v[28:31]
    v_cvt_pk_bf16_f32 v90, v60, v61
    v_cvt_pk_bf16_f32 v91, v62, v63
    s_waitcnt vmcnt(10)
    v_mfma_f32_16x16x32_bf16 v[16:19], a[32:35], v[164:167], v[16:19]
    buffer_store_dwordx4 v[88:91], v208, s[36:39], s76 offen
    v_mfma_f32_16x16x32_bf16 v[16:19], a[48:51], v[168:171], v[16:19]
    buffer_load_dwordx4 v[156:159], v212, s[28:31], s67 offen offset:1024 sc1
    v_mfma_f32_16x16x32_bf16 v[20:23], a[36:39], v[164:167], v[20:23]
    ds_write_b128 v210, v[96:99] offset:33792
    v_mfma_f32_16x16x32_bf16 v[20:23], a[52:55], v[168:171], v[20:23]
    s_waitcnt vmcnt(10)
    v_cmp_eq_u32 vcc, 1, v14
    v_mfma_f32_16x16x32_bf16 v[24:27], a[40:43], v[164:167], v[24:27]
    s_cmp_lg_u64 vcc, s[10:11]
    s_cbranch_scc1 L_waitc4
L_goc4:
    v_mfma_f32_16x16x32_bf16 v[24:27], a[56:59], v[168:171], v[24:27]
    s_add_u32 s67, s87, 0
    buffer_load_dwordx4 v[160:163], v211, s[28:31], s67 offen offset:0 sc1
    v_mfma_f32_16x16x32_bf16 v[28:31], a[44:47], v[164:167], v[28:31]
    ds_write_b128 v210, v[100:103] offset:34848
    v_mfma_f32_16x16x32_bf16 v[28:31], a[60:63], v[168:171], v[28:31]
    s_waitcnt vmcnt(10)
    v_mfma_f32_16x16x32_bf16 v[16:19], a[64:67], v[172:175], v[16:19]
    v_mfma_f32_16x16x32_bf16 v[16:19], a[80:83], v[176:179], v[16:19]
    buffer_load_dwordx4 v[164:167], v211, s[28:31], s67 offen offset:1024 sc1
    v_mfma_f32_16x16x32_bf16 v[20:23], a[68:71], v[172:175], v[20:23]
    ds_write_b128 v210, v[104:107] offset:35904
    v_mfma_f32_16x16x32_bf16 v[20:23], a[84:87], v[176:179], v[20:23]
    v_mfma_f32_16x16x32_bf16 v[24:27], a[72:75], v[172:175], v[24:27]
    v_mfma_f32_16x16x32_bf16 v[24:27], a[88:91], v[176:179], v[24:27]
    buffer_load_dwordx4 v[168:171], v211, s[28:31], s67 offen offset:2048 sc1
    v_mfma_f32_16x16x32_bf16 v[28:31], a[76:79], v[172:175], v[28:31]
    ds_write_b128 v210, v[108:111] offset:36960
    v_mfma_f32_16x16x32_bf16 v[28:31], a[92:95], v[176:179], v[28:31]
    s_waitcnt vmcnt(10)
    v_mfma_f32_16x16x32_bf16 v[16:19], a[96:99], v[180:183], v[16:19]
    v_mfma_f32_16x16x32_bf16 v[16:19], a[112:115], v[184:187], v[16:19]
    buffer_load_dwordx4 v[172:175], v211, s[28:31], s67 offen offset:3072 sc1
    v_mfma_f32_16x16x32_bf16 v[20:23], a[100:103], v[180:183], v[20:23]
    s_add_u32 s67, s87, 4096
    v_mfma_f32_16x16x32_bf16 v[20:23], a[116:119], v[184:187], v[20:23]
    v_mfma_f32_16x16x32_bf16 v[24:27], a[104:107], v[180:183], v[24:27]
    v_mfma_f32_16x16x32_bf16 v[24:27], a[120:123], v[184:187], v[24:27]
    buffer_load_dwordx4 v[176:179], v211, s[28:31], s67 offen offset:0 sc1
    v_mfma_f32_16x16x32_bf16 v[28:31], a[108:111], v[180:183], v[28:31]
    v_mfma_f32_16x16x32_bf16 v[28:31], a[124:127], v[184:187], v[28:31]
    s_waitcnt vmcnt(10)
    v_mfma_f32_16x16x32_bf16 v[16:19], a[128:131], v[188:191], v[16:19]
    v_mfma_f32_16x16x32_bf16 v[16:19], a[144:147], v[192:195], v[16:19]
    buffer_load_dwordx4 v[180:183], v211, s[28:31], s67 offen offset:1024 sc1
    v_mfma_f32_16x16x32_bf16 v[20:23], a[132:135], v[188:191], v[20:23]
    v_mfma_f32_16x16x32_bf16 v[20:23], a[148:151], v[192:195], v[20:23]
    v_mfma_f32_16x16x32_bf16 v[24:27], a[136:139], v[188:191], v[24:27]
    v_mfma_f32_16x16x32_bf16 v[24:27], a[152:155], v[192:195], v[24:27]
    buffer_load_dwordx4 v[184:187], v211, s[28:31], s67 offen offset:2048 sc1
    v_mfma_f32_16x16x32_bf16 v[28:31], a[140:143], v[188:191], v[28:31]
    v_mfma_f32_16x16x32_bf16 v[28:31], a[156:159], v[192:195], v[28:31]
    s_waitcnt vmcnt(10)
    v_mfma_f32_16x16x32_bf16 v[16:19], a[160:163], v[144:147], v[16:19]
    v_mfma_f32_16x16x32_bf16 v[16:19], a[176:179], v[148:151], v[16:19]
    buffer_load_dwordx4 v[188:191], v211, s[28:31], s67 offen offset:3072 sc1
    v_mfma_f32_16x16x32_bf16 v[20:23], a[164:167], v[144:147], v[20:23]
    v_mfma_f32_16x16x32_bf16 v[20:23], a[180:183], v[148:151], v[20:23]
    v_mfma_f32_16x16x32_bf16 v[24:27], a[168:171], v[144:147], v[24:27]
    s_add_u32 s67, s87, 8192
    v_mfma_f32_16x16x32_bf16 v[24:27], a[184:187], v[148:151], v[24:27]
    v_mfma_f32_16x16x32_bf16 v[28:31], a[172:175], v[144:147], v[28:31]
    v_mfma_f32_16x16x32_bf16 v[28:31], a[188:191], v[148:151], v[28:31]
    s_waitcnt vmcnt(8)
    v_mfma_f32_16x16x32_bf16 v[16:19], a[192:195], v[152:155], v[16:19]
    v_mfma_f32_16x16x32_bf16 v[16:19], a[208:211], v[156:159], v[16:19]
    buffer_load_dwordx4 v[192:195], v211, s[28:31], s67 offen offset:0 sc1
    v_mfma_f32_16x16x32_bf16 v[20:23], a[196:199], v[152:155], v[20:23]
    v_mfma_f32_16x16x32_bf16 v[20:23], a[212:215], v[156:159], v[20:23]
    v_mfma_f32_16x16x32_bf16 v[24:27], a[200:203], v[152:155], v[24:27]
    v_mfma_f32_16x16x32_bf16 v[24:27], a[216:219], v[156:159], v[24:27]
    buffer_load_dwordx4 v[144:147], v211, s[28:31], s67 offen offset:1024 sc1
    v_mfma_f32_16x16x32_bf16 v[28:31], a[204:207], v[152:155], v[28:31]
    v_mfma_f32_16x16x32_bf16 v[28:31], a[220:223], v[156:159], v[28:31]
L_rowc4:
    s_waitcnt vmcnt(8)
    v_mfma_f32_16x16x32_bf16 v[32:35], a[0:3], v[160:163], 0
    v_mfma_f32_16x16x32_bf16 v[32:35], a[16:19], v[164:167], v[32:35]
    buffer_load_dwordx4 v[148:151], v211, s[28:31], s67 offen offset:2048 sc1
    v_mfma_f32_16x16x32_bf16 v[36:39], a[4:7], v[160:163], 0
    v_mfma_f32_16x16x32_bf16 v[36:39], a[20:23], v[164:167], v[36:39]
    v_mfma_f32_16x16x32_bf16 v[40:43], a[8:11], v[160:163], 0
    v_mfma_f32_16x16x32_bf16 v[40:43], a[24:27], v[164:167], v[40:43]
    v_mfma_f32_16x16x32_bf16 v[44:47], a[12:15], v[160:163], 0
    v_mfma_f32_16x16x32_bf16 v[44:47], a[28:31], v[164:167], v[44:47]
    s_waitcnt vmcnt(7)
    v_mfma_f32_16x16x32_bf16 v[32:35], a[32:35], v[168:171], v[32:35]
    v_mfma_f32_16x16x32_bf16 v[32:35], a[48:51], v[172:175], v[32:35]
    buffer_load_dwordx4 v[152:155], v211, s[28:31], s67 offen offset:3072 sc1
    v_mfma_f32_16x16x32_bf16 v[36:39], a[36:39], v[168:171], v[36:39]
    ds_write_b128 v210, v[16:19] offset:50688
    v_mfma_f32_16x16x32_bf16 v[36:39], a[52:55], v[172:175], v[36:39]
    s_add_u32 s67, s87, 12288
    v_mfma_f32_16x16x32_bf16 v[40:43], a[40:43], v[168:171], v[40:43]
    v_mfma_f32_16x16x32_bf16 v[40:43], a[56:59], v[172:175], v[40:43]
    buffer_load_dwordx4 v[156:159], v212, s[28:31], s67 offen offset:0 sc1
    v_mfma_f32_16x16x32_bf16 v[44:47], a[44:47], v[168:171], v[44:47]
    ds_write_b128 v210, v[20:23] offset:51744
    v_mfma_f32_16x16x32_bf16 v[44:47], a[60:63], v[172:175], v[44:47]
    s_waitcnt vmcnt(7)
    v_mfma_f32_16x16x32_bf16 v[32:35], a[64:67], v[176:179], v[32:35]
    v_mfma_f32_16x16x32_bf16 v[32:35], a[80:83], v[180:183], v[32:35]
    buffer_load_dwordx4 v[160:163], v212, s[28:31], s67 offen offset:1024 sc1
    v_mfma_f32_16x16x32_bf16 v[36:39], a[68:71], v[176:179], v[36:39]
    ds_write_b128 v210, v[24:27] offset:52800
    v_mfma_f32_16x16x32_bf16 v[36:39], a[84:87], v[180:183], v[36:39]
    v_mfma_f32_16x16x32_bf16 v[40:43], a[72:75], v[176:179], v[40:43]
    v_mfma_f32_16x16x32_bf16 v[40:43], a[88:91], v[180:183], v[40:43]
    v_mfma_f32_16x16x32_bf16 v[44:47], a[76:79], v[176:179], v[44:47]
    ds_write_b128 v210, v[28:31] offset:53856
    v_mfma_f32_16x16x32_bf16 v[44:47], a[92:95], v[180:183], v[44:47]
    s_waitcnt vmcnt(6)
    v_mfma_f32_16x16x32_bf16 v[32:35], a[96:99], v[184:187], v[32:35]
    v_mfma_f32_16x16x32_bf16 v[32:35], a[112:115], v[188:191], v[32:35]
    v_mfma_f32_16x16x32_bf16 v[36:39], a[100:103], v[184:187], v[36:39]
    v_mfma_f32_16x16x32_bf16 v[36:39], a[116:119], v[188:191], v[36:39]
    s_waitcnt lgkmcnt(0)
    s_barrier
    v_mfma_f32_16x16x32_bf16 v[40:43], a[104:107], v[184:187], v[40:43]
    ds_read_b128 v[56:59], v209 offset:33792
    v_mfma_f32_16x16x32_bf16 v[40:43], a[120:123], v[188:191], v[40:43]
    ds_read_b128 v[60:63], v209 offset:34048
    v_mfma_f32_16x16x32_bf16 v[44:47], a[108:111], v[184:187], v[44:47]
    ds_read_b128 v[64:67], v209 offset:38016
    v_mfma_f32_16x16x32_bf16 v[44:47], a[124:127], v[188:191], v[44:47]
    ds_read_b128 v[68:71], v209 offset:38272
    s_waitcnt vmcnt(4)
    v_mfma_f32_16x16x32_bf16 v[32:35], a[128:131], v[192:195], v[32:35]
    ds_read_b128 v[72:75], v209 offset:42240
    v_mfma_f32_16x16x32_bf16 v[32:35], a[144:147], v[144:147], v[32:35]
    ds_read_b128 v[76:79], v209 offset:42496
    v_mfma_f32_16x16x32_bf16 v[36:39], a[132:135], v[192:195], v[36:39]
    ds_read_b128 v[80:83], v209 offset:46464
    v_mfma_f32_16x16x32_bf16 v[36:39], a[148:151], v[144:147], v[36:39]
    ds_read_b128 v[84:87], v209 offset:46720
    v_mfma_f32_16x16x32_bf16 v[40:43], a[136:139], v[192:195], v[40:43]
    v_mfma_f32_16x16x32_bf16 v[40:43], a[152:155], v[144:147], v[40:43]
    v_mfma_f32_16x16x32_bf16 v[44:47], a[140:143], v[192:195], v[44:47]
    s_waitcnt lgkmcnt(4)
    v_add_f32 v56, v56, v64
    v_add_f32 v57, v57, v65
    v_mfma_f32_16x16x32_bf16 v[44:47], a[156:159], v[144:147], v[44:47]
    v_add_f32 v58, v58, v66
    v_add_f32 v59, v59, v67
    s_waitcnt vmcnt(0)
    v_mfma_f32_16x16x32_bf16 v[32:35], a[160:163], v[148:151], v[32:35]
    v_add_f32 v60, v60, v68
    v_add_f32 v61, v61, v69
    v_mfma_f32_16x16x32_bf16 v[32:35], a[176:179], v[152:155], v[32:35]
    v_add_f32 v62, v62, v70
    v_add_f32 v63, v63, v71
    v_mfma_f32_16x16x32_bf16 v[32:35], a[192:195], v[156:159], v[32:35]
    s_waitcnt lgkmcnt(2)
    v_add_f32 v56, v56, v72
    v_add_f32 v57, v57, v73
    v_mfma_f32_16x16x32_bf16 v[32:35], a[208:211], v[160:163], v[32:35]
    v_add_f32 v58, v58, v74
    v_add_f32 v59, v59, v75
    v_mfma_f32_16x16x32_bf16 v[36:39], a[164:167], v[148:151], v[36:39]
    v_add_f32 v60, v60, v76
    v_add_f32 v61, v61, v77
    v_mfma_f32_16x16x32_bf16 v[36:39], a[180:183], v[152:155], v[36:39]
    v_add_f32 v62, v62, v78
    v_add_f32 v63, v63, v79
    v_mfma_f32_16x16x32_bf16 v[36:39], a[196:199], v[156:159], v[36:39]
    s_waitcnt lgkmcnt(0)
    v_add_f32 v56, v56, v80
    v_add_f32 v57, v57, v81
    v_mfma_f32_16x16x32_bf16 v[36:39], a[212:215], v[160:163], v[36:39]
    v_add_f32 v58, v58, v82
    v_add_f32 v59, v59, v83
    v_mfma_f32_16x16x32_bf16 v[40:43], a[168:171], v[148:151], v[40:43]
    v_add_f32 v60, v60, v84
    v_add_f32 v61, v61, v85
    v_mfma_f32_16x16x32_bf16 v[40:43], a[184:187], v[152:155], v[40:43]
    v_add_f32 v62, v62, v86
    v_add_f32 v63, v63, v87
    v_mfma_f32_16x16x32_bf16 v[40:43], a[200:203], v[156:159], v[40:43]
    v_cvt_pk_bf16_f32 v88, v56, v57
    v_cvt_pk_bf16_f32 v89, v58, v59
    v_mfma_f32_16x16x32_bf16 v[40:43], a[216:219], v[160:163], v[40:43]
    ds_write_b128 v210, v[32:35] offset:0
    v_mfma_f32_16x16x32_bf16 v[44:47], a[172:175], v[148:151], v[44:47]
    v_cvt_pk_bf16_f32 v90, v60, v61
    v_cvt_pk_bf16_f32 v91, v62, v63
    v_mfma_f32_16x16x32_bf16 v[44:47], a[188:191], v[152:155], v[44:47]
    buffer_store_dwordx4 v[88:91], v208, s[36:39], s77 offen
    v_mfma_f32_16x16x32_bf16 v[44:47], a[204:207], v[156:159], v[44:47]
    v_mfma_f32_16x16x32_bf16 v[44:47], a[220:223], v[160:163], v[44:47]
    ds_write_b128 v210, v[36:39] offset:1056
    s_nop 2
    ds_write_b128 v210, v[40:43] offset:2112
    s_nop 3
    ds_write_b128 v210, v[44:47] offset:3168
    s_cmp_ge_u32 s48, 2
    s_waitcnt lgkmcnt(0)
    s_barrier
    s_cbranch_scc1 L_fin
    ds_read_b128 v[56:59], v209 offset:0
    ds_read_b128 v[60:63], v209 offset:256
    ds_read_b128 v[64:67], v209 offset:4224
    ds_read_b128 v[68:71], v209 offset:4480
    ds_read_b128 v[72:75], v209 offset:8448
    ds_read_b128 v[76:79], v209 offset:8704
    ds_read_b128 v[80:83], v209 offset:12672
    ds_read_b128 v[84:87], v209 offset:12928
    s_waitcnt lgkmcnt(4)
    v_pk_add_f32 v[56:57], v[56:57], v[64:65]
    v_pk_add_f32 v[58:59], v[58:59], v[66:67]
    v_pk_add_f32 v[60:61], v[60:61], v[68:69]
    v_pk_add_f32 v[62:63], v[62:63], v[70:71]
    s_waitcnt lgkmcnt(2)
    v_pk_add_f32 v[56:57], v[56:57], v[72:73]
    v_pk_add_f32 v[58:59], v[58:59], v[74:75]
    v_pk_add_f32 v[60:61], v[60:61], v[76:77]
    v_pk_add_f32 v[62:63], v[62:63], v[78:79]
    s_waitcnt lgkmcnt(0)
    v_pk_add_f32 v[56:57], v[56:57], v[80:81]
    v_pk_add_f32 v[58:59], v[58:59], v[82:83]
    v_pk_add_f32 v[60:61], v[60:61], v[84:85]
    v_pk_add_f32 v[62:63], v[62:63], v[86:87]
    v_cvt_pk_bf16_f32 v88, v56, v57
    v_cvt_pk_bf16_f32 v89, v58, v59
    v_cvt_pk_bf16_f32 v90, v60, v61
    v_cvt_pk_bf16_f32 v91, v62, v63
    buffer_store_dwordx4 v[88:91], v208, s[36:39], s78 offen
L_fin:
L_end:
    s_endpgm
L_slow1:
    s_mov_b32 s68, 0
L_slow1_l:
    buffer_load_dword v14, off, s[40:43], 0 sc1
    s_waitcnt vmcnt(0)
    v_cmp_eq_u32 vcc, 1, v14
    s_bcnt1_i32_b64 s58, vcc
    s_cmp_eq_u32 s58, 64
    s_cbranch_scc1 L_back1
    s_add_u32 s68, s68, 1
    s_cmp_gt_u32 s68, 200000
    s_cbranch_scc1 L_back1
    s_sleep 16
    s_branch L_slow1_l
L_helper:
    v_lshrrev_b32 v1, 6, v0
    v_and_b32 v0, 63, v0
    s_and_b32 s62, s2, 7
    s_lshr_b32 s63, s2, 3
    v_readfirstlane_b32 s48, v1
    s_mov_b32 s23, 0x20000
    s_mov_b32 s59, s63
    s_and_b32 s58, s62, 3
    s_mul_i32 s64, s58, 31
    s_mul_i32 s65, s59, 5
    s_add_u32 s58, s58, s65
    s_lshl_b32 s58, s58, 1
    s_mov_b32 s84, 621367956
    s_mov_b32 s85, 164008
    s_lshr_b64 s[84:85], s[84:85], s58
    s_and_b32 s84, s84, 3
    s_lshl_b32 s84, s84, 1
    s_add_u32 s64, s64, s84
    s_lshr_b32 s65, s62, 2
    s_mul_i32 s65, s65, 5
    s_add_u32 s65, s65, s59
    s_and_b32 s58, s62, 3
    s_lshl_b32 s86, s59, 2
    s_add_u32 s58, s58, s86
    s_lshl_b32 s58, s58, 1
    s_mov_b32 s86, 80528179
    s_mov_b32 s87, 16
    s_lshr_b64 s[86:87], s[86:87], s58
    s_and_b32 s86, s86, 3
    s_sub_u32 s87, 6, s86
    s_sub_u32 s86, 0, s64
    s_and_b32 s86, s86, 3
    s_mul_i32 s86, s86, 5
    s_add_u32 s64, s64, s86
    s_add_u32 s61, s64, s87
    s_mov_b32 s34, 2211840
    s_cmp_lg_u32 s2, 7
    s_waitcnt lgkmcnt(0)
    s_cbranch_scc1 L_noreset
    s_add_u32 s44, s16, 12582912
    s_addc_u32 s45, s17, 0
    s_mov_b32 s46, 40960
    s_mov_b32 s47, 0x20000
    s_mov_b32 s40, s14
    s_mov_b32 s41, s15
    s_mov_b32 s42, 4
    s_mov_b32 s43, 0x20000
    v_lshlrev_b32 v9, 4, v0
    v_lshlrev_b32 v10, 2, v0
    v_mov_b64 v[16:17], 0
    v_mov_b64 v[18:19], 0
    v_mov_b32 v11, 1
    s_lshl_b32 s58, s48, 12
    s_add_u32 s59, s58, 16384
    buffer_load_dword v8, v10, s[40:43], s58 offen
    buffer_store_dwordx4 v[16:19], v9, s[44:47], s58 offen offset:0 sc1
    buffer_store_dwordx4 v[16:19], v9, s[44:47], s58 offen offset:1024 sc1
    buffer_store_dwordx4 v[16:19], v9, s[44:47], s58 offen offset:2048 sc1
    buffer_store_dwordx4 v[16:19], v9, s[44:47], s58 offen offset:3072 sc1
    buffer_store_dwordx4 v[16:19], v9, s[44:47], s59 offen offset:0 sc1
    buffer_store_dwordx4 v[16:19], v9, s[44:47], s59 offen offset:1024 sc1
    buffer_store_dwordx4 v[16:19], v9, s[44:47], s59 offen offset:2048 sc1
    buffer_store_dwordx4 v[16:19], v9, s[44:47], s59 offen offset:3072 sc1
    s_add_u32 s59, s59, 16384
    buffer_store_dwordx4 v[16:19], v9, s[44:47], s59 offen offset:0 sc1
    buffer_store_dwordx4 v[16:19], v9, s[44:47], s59 offen offset:1024 sc1
    buffer_store_dwordx4 v[16:19], v9, s[44:47], s59 offen offset:2048 sc1
    buffer_store_dwordx4 v[16:19], v9, s[44:47], s59 offen offset:3072 sc1
    s_waitcnt vmcnt(0)
    s_barrier
    buffer_store_dword v11, v10, s[40:43], s58 offen sc1
L_noreset:
    s_sub_u32 s51, s2, 8
    s_cselect_b32 s58, 40, 0
    s_add_u32 s51, s51, s58
    s_lshl_b32 s51, s51, 2
    s_add_u32 s51, s51, s48
    s_mov_b32 s67, s51
    s_add_u32 s51, s51, 226
    s_movk_i32 s73, 854
L_touch1:
    s_mul_hi_u32 s58, s51, 49941481
    s_mul_i32 s59, s58, 86
    s_sub_u32 s59, s51, s59
    s_cmp_lt_u32 s59, 27
    s_cselect_b32 s20, s6, s8
    s_cselect_b32 s21, s7, s9
    s_cselect_b32 s52, 0, 27
    s_sub_u32 s52, s59, s52
    s_lshl_b32 s52, s52, 13
    s_mul_i32 s53, s58, 221184
    s_add_u32 s52, s52, s53
    s_sub_u32 s53, s59, 54
    s_mul_i32 s53, s53, 81920
    s_lshl_b32 s58, s58, 7
    s_add_u32 s53, s53, s58
    s_mov_b32 s22, 2211840
    s_movk_i32 s58, 128
    s_cmp_ge_u32 s59, 54
    s_cselect_b32 s20, s4, s20
    s_cselect_b32 s21, s5, s21
    s_cselect_b32 s22, 2621440, s22
    s_cselect_b32 s52, s53, s52
    s_cselect_b32 s58, 1280, s58
    v_mul_u32_u24 v9, s58, v0
    s_add_u32 s51, s51, 160
    buffer_load_dword v8, v9, s[20:23], s52 offen
    s_waitcnt vmcnt(1)
    s_cmp_lt_u32 s51, s73
    s_cbranch_scc1 L_touch1
    s_cmp_eq_u32 s73, 860
    s_cbranch_scc1 L_hsetup
    s_mov_b32 s20, s10
    s_mov_b32 s21, s11
    s_mov_b32 s22, 2211840
    v_lshlrev_b32 v9, 7, v0
    s_lshl_b32 s52, s67, 13
    buffer_load_dword v8, v9, s[20:23], s52 offen
    s_add_u32 s52, s52, 1310720
    s_waitcnt vmcnt(1)
    buffer_load_dword v8, v9, s[20:23], s52 offen
    s_waitcnt vmcnt(1)
    s_movk_i32 s73, 860
    s_cmp_lt_u32 s51, 860
    s_cbranch_scc1 L_touch1
L_hsetup:
L_hrest:
    s_sub_u32 s58, 0, s64
    s_and_b32 s58, s58, 3
    s_add_u32 s58, s64, s58
    s_add_u32 s83, s58, 0
    s_sub_u32 s58, 2, s64
    s_and_b32 s58, s58, 3
    s_add_u32 s58, s64, s58
    s_add_u32 s84, s58, 256
    s_sub_u32 s58, 1, s64
    s_and_b32 s58, s58, 3
    s_add_u32 s58, s64, s58
    s_add_u32 s85, s58, 512
    s_sub_u32 s58, 3, s64
    s_and_b32 s58, s58, 3
    s_add_u32 s58, s64, s58
    s_add_u32 s86, s58, 768
    s_add_u32 s58, s64, 4
    s_and_b32 s59, s58, 1
    s_lshl_b32 s59, s59, 9
    s_and_b32 s60, s58, 2
    s_lshl_b32 s60, s60, 7
    s_add_u32 s58, s58, s59
    s_add_u32 s58, s58, s60
    s_max_u32 s87, s86, s58
    s_min_u32 s58, s86, s58
    s_max_u32 s86, s85, s58
    s_min_u32 s58, s85, s58
    s_max_u32 s85, s84, s58
    s_min_u32 s58, s84, s58
    s_mov_b32 s84, s58
    s_add_u32 s58, s64, 5
    s_and_b32 s59, s58, 1
    s_lshl_b32 s59, s59, 9
    s_and_b32 s60, s58, 2
    s_lshl_b32 s60, s60, 7
    s_add_u32 s58, s58, s59
    s_add_u32 s58, s58, s60
    s_max_u32 s88, s87, s58
    s_min_u32 s58, s87, s58
    s_max_u32 s87, s86, s58
    s_min_u32 s58, s86, s58
    s_max_u32 s86, s85, s58
    s_min_u32 s58, s85, s58
    s_max_u32 s85, s84, s58
    s_min_u32 s58, s84, s58
    s_mov_b32 s84, s58
    s_mov_b32 s32, s10
    s_mov_b32 s33, s11
    s_mov_b32 s35, 0x20000
    s_mov_b32 s36, s12
    s_mov_b32 s37, s13
    s_mov_b32 s38, 2621440
    s_mov_b32 s39, 0x20000
    s_mov_b32 s40, s14
    s_mov_b32 s41, s15
    s_mov_b32 s42, 4
    s_mov_b32 s43, 0x20000
    s_add_u32 s44, s16, 12582912
    s_addc_u32 s45, s17, 0
    s_mov_b32 s46, 40960
    s_mov_b32 s47, 0x20000
    s_mov_b32 s28, s16
    s_mov_b32 s29, s17
    s_mov_b32 s30, 7077888
    s_mov_b32 s31, 0x20000
    s_movk_i32 s81, 8192
    s_movk_i32 s3, 16384
    s_movk_i32 s75, 24576
    s_lshl_b32 s69, s48, 11
    s_mul_i32 s58, s48, 14336
    v_lshl_add_u32 v65, v0, 4, s58
    v_accvgpr_write_b32 a227, v65
    s_cmp_eq_u32 s48, 3
    s_cselect_b32 s58, 2130706432, 0
    v_or_b32 v65, s58, v65
    v_accvgpr_write_b32 a228, v65
    v_lshrrev_b32 v65, 3, v0
    v_and_b32 v66, 7, v0
    v_mul_u32_u24 v67, 1280, v65
    v_lshl_add_u32 v67, v66, 4, v67
    s_lshl_b32 s59, s65, 7
    s_mul_i32 s58, s48, 573440
    s_add_u32 s58, s58, s59
    v_lshrrev_b32 v68, 4, v0
    v_lshlrev_b32 v68, 5, v68
    v_xor_b32 v68, v68, v67
    v_add_u32 v2, s58, v68
    s_and_b32 s58, s48, 1
    s_mul_i32 s60, s58, 10240
    s_add_u32 s60, s60, s59
    v_add_u32 v67, s60, v67
    v_accvgpr_write_b32 a224, v67
    s_lshl_b32 s58, s58, 3
    v_add_u32 v65, s58, v65
    v_and_b32 v67, 1, v66
    v_mad_u32_u24 v65, v65, 9, v67
    v_and_b32 v65, 15, v65
    v_lshl_add_u32 v65, v67, 5, v65
    v_lshrrev_b32 v66, 1, v66
    v_mul_u32_u24 v66, 66, v66
    v_add_u32 v65, v65, v66
    s_lshr_b32 s58, s48, 1
    s_mul_i32 s58, s58, 16896
    v_lshl_add_u32 v65, v65, 4, s58
    v_accvgpr_write_b32 a225, v65
    v_and_b32 v65, 15, v0
    v_lshrrev_b32 v66, 4, v0
    v_lshrrev_b32 v67, 5, v0
    v_mad_u32_u24 v67, v65, 9, v67
    v_and_b32 v67, 15, v67
    v_lshl_add_u32 v67, v66, 4, v67
    s_mul_i32 s58, s48, 4224
    v_lshl_add_u32 v67, v67, 4, s58
    v_accvgpr_write_b32 a226, v67
    v_lshrrev_b32 v67, 2, v0
    v_lshlrev_b32 v67, 7, v67
    v_and_b32 v68, 3, v0
    v_lshl_add_u32 v67, v68, 3, v67
    v_bfe_u32 v68, v0, 3, 2
    v_lshl_add_u32 v67, v68, 5, v67
    s_add_u32 s58, s69, 49152
    v_add_u32 v3, s58, v67
    s_lshl_b32 s58, s48, 7
    v_lshl_add_u32 v67, v0, 2, s58
    s_cmp_lt_u32 s48, 3
    s_cselect_b32 s72, 14, 12
    v_mov_b32 v64, 2147483392
    v_cmp_gt_u32 vcc, s72, v0
    s_nop 1
    v_cndmask_b32 v5, v64, v67, vcc
    s_mov_b64 s[10:11], vcc
    s_lshr_b32 s58, s83, 8
    s_lshl_b32 s58, s58, 13
    s_and_b32 s59, s83, 0xf8
    s_lshl_b32 s59, s59, 6
    s_add_u32 s4, s58, s59
    s_and_b32 s83, s83, 0xff
    s_lshr_b32 s58, s84, 8
    s_lshl_b32 s58, s58, 13
    s_and_b32 s59, s84, 0xf8
    s_lshl_b32 s59, s59, 6
    s_add_u32 s5, s58, s59
    s_and_b32 s84, s84, 0xff
    s_lshr_b32 s58, s85, 8
    s_lshl_b32 s58, s58, 13
    s_and_b32 s59, s85, 0xf8
    s_lshl_b32 s59, s59, 6
    s_add_u32 s6, s58, s59
    s_and_b32 s85, s85, 0xff
    s_lshr_b32 s58, s86, 8
    s_lshl_b32 s58, s58, 13
    s_and_b32 s59, s86, 0xf8
    s_lshl_b32 s59, s59, 6
    s_add_u32 s7, s58, s59
    s_and_b32 s86, s86, 0xff
    s_lshr_b32 s58, s87, 8
    s_lshl_b32 s58, s58, 13
    s_and_b32 s59, s87, 0xf8
    s_lshl_b32 s59, s59, 6
    s_add_u32 s8, s58, s59
    s_and_b32 s87, s87, 0xff
    s_lshr_b32 s58, s88, 8
    s_lshl_b32 s58, s58, 13
    s_and_b32 s59, s88, 0xf8
    s_lshl_b32 s59, s59, 6
    s_add_u32 s9, s58, s59
    s_and_b32 s88, s88, 0xff
    s_cmp_lt_u32 s48, 2
    s_cselect_b32 s76, s83, s84
    s_cmp_ge_u32 s76, s61
    s_cselect_b32 s76, 0x1000, s76
    s_mul_i32 s76, s76, 20480
    s_cmp_lt_u32 s48, 2
    s_cselect_b32 s77, s85, s86
    s_cmp_ge_u32 s77, s61
    s_cselect_b32 s77, 0x1000, s77
    s_mul_i32 s77, s77, 20480
    s_cmp_lt_u32 s48, 2
    s_cselect_b32 s78, s87, s88
    s_cmp_ge_u32 s78, s61
    s_cselect_b32 s78, 0x1000, s78
    s_mul_i32 s78, s78, 20480
    s_mul_i32 s83, s83, 55296
    s_mul_i32 s84, s84, 55296
    s_mul_i32 s85, s85, 55296
    s_mul_i32 s86, s86, 55296
    s_mul_i32 s87, s87, 55296
    s_mul_i32 s88, s88, 55296
    v_xor_b32 v9, 32, v3
    v_xor_b32 v10, 64, v3
    v_xor_b32 v11, 96, v3
    v_add_u32 v1, 49152, v3
    v_xor_b32 v4, 32, v1
    v_xor_b32 v6, 64, v1
    v_xor_b32 v250, 96, v1
    v_add_u32 v251, 9216, v2
    s_add_u32 m0, s69, 49152
    s_mov_b32 s66, 0
    s_nop 0
    buffer_load_dwordx4 v2, s[32:35], s66 offen lds
    buffer_load_dwordx4 v251, s[32:35], s66 offen offset:1024 lds
    s_add_u32 m0, s69, 57344
    s_mov_b32 s66, 20480
    s_nop 0
    buffer_load_dwordx4 v2, s[32:35], s66 offen lds
    buffer_load_dwordx4 v251, s[32:35], s66 offen offset:1024 lds
    s_add_u32 m0, s69, 65536
    s_mov_b32 s66, 40960
    s_nop 0
    buffer_load_dwordx4 v2, s[32:35], s66 offen lds
    buffer_load_dwordx4 v251, s[32:35], s66 offen offset:1024 lds
    s_add_u32 m0, s69, 73728
    s_mov_b32 s66, 61440
    s_nop 0
    buffer_load_dwordx4 v2, s[32:35], s66 offen lds
    buffer_load_dwordx4 v251, s[32:35], s66 offen offset:1024 lds
    s_add_u32 m0, s69, 81920
    s_mov_b32 s66, 81920
    s_nop 0
    buffer_load_dwordx4 v2, s[32:35], s66 offen lds
    buffer_load_dwordx4 v251, s[32:35], s66 offen offset:1024 lds
    s_add_u32 m0, s69, 90112
    s_mov_b32 s66, 102400
    s_nop 0
    buffer_load_dwordx4 v2, s[32:35], s66 offen lds
    buffer_load_dwordx4 v251, s[32:35], s66 offen offset:1024 lds
    s_add_u32 m0, s69, 98304
    s_mov_b32 s66, 122880
    s_nop 0
    buffer_load_dwordx4 v2, s[32:35], s66 offen lds
    buffer_load_dwordx4 v251, s[32:35], s66 offen offset:1024 lds
    s_add_u32 m0, s69, 106496
    s_mov_b32 s66, 143360
    s_nop 0
    buffer_load_dwordx4 v2, s[32:35], s66 offen lds
    buffer_load_dwordx4 v251, s[32:35], s66 offen offset:1024 lds
    s_add_u32 m0, s69, 114688
    s_mov_b32 s66, 163840
    s_nop 0
    buffer_load_dwordx4 v2, s[32:35], s66 offen lds
    buffer_load_dwordx4 v251, s[32:35], s66 offen offset:1024 lds
    s_add_u32 m0, s69, 122880
    s_mov_b32 s66, 184320
    s_nop 0
    buffer_load_dwordx4 v2, s[32:35], s66 offen lds
    buffer_load_dwordx4 v251, s[32:35], s66 offen offset:1024 lds
    s_add_u32 m0, s69, 131072
    s_mov_b32 s66, 204800
    s_nop 0
    buffer_load_dwordx4 v2, s[32:35], s66 offen lds
    buffer_load_dwordx4 v251, s[32:35], s66 offen offset:1024 lds
    s_add_u32 m0, s69, 139264
    s_mov_b32 s66, 225280
    s_nop 0
    buffer_load_dwordx4 v2, s[32:35], s66 offen lds
    buffer_load_dwordx4 v251, s[32:35], s66 offen offset:1024 lds
    s_add_u32 m0, s69, 147456
    s_mov_b32 s66, 245760
    s_nop 0
    buffer_load_dwordx4 v2, s[32:35], s66 offen lds
    buffer_load_dwordx4 v251, s[32:35], s66 offen offset:1024 lds
    s_add_u32 m0, s69, 155648
    s_mov_b32 s66, 266240
    s_nop 0
    buffer_load_dwordx4 v2, s[32:35], s66 offen lds
    buffer_load_dwordx4 v251, s[32:35], s66 offen offset:1024 lds
    s_waitcnt vmcnt(26)
    ds_read_b64_tr_b16 a[0:1], v3 offset:0
    ds_read_b64_tr_b16 a[4:5], v9 offset:0
    ds_read_b64_tr_b16 a[8:9], v10 offset:0
    ds_read_b64_tr_b16 a[12:13], v11 offset:0
    s_waitcnt vmcnt(24)
    ds_read_b64_tr_b16 a[2:3], v3 offset:8192
    ds_read_b64_tr_b16 a[6:7], v9 offset:8192
    ds_read_b64_tr_b16 a[10:11], v10 offset:8192
    ds_read_b64_tr_b16 a[14:15], v11 offset:8192
    s_waitcnt lgkmcnt(0)
    s_add_u32 m0, s69, 49152
    s_mov_b32 s66, 286720
    s_nop 0
    buffer_load_dwordx4 v2, s[32:35], s66 offen lds
    buffer_load_dwordx4 v251, s[32:35], s66 offen offset:1024 lds
    s_add_u32 m0, s69, 57344
    s_mov_b32 s66, 307200
    s_nop 0
    buffer_load_dwordx4 v2, s[32:35], s66 offen lds
    buffer_load_dwordx4 v251, s[32:35], s66 offen offset:1024 lds
    s_waitcnt vmcnt(26)
    ds_read_b64_tr_b16 a[16:17], v3 offset:16384
    ds_read_b64_tr_b16 a[20:21], v9 offset:16384
    ds_read_b64_tr_b16 a[24:25], v10 offset:16384
    ds_read_b64_tr_b16 a[28:29], v11 offset:16384
    s_waitcnt vmcnt(24)
    ds_read_b64_tr_b16 a[18:19], v3 offset:24576
    ds_read_b64_tr_b16 a[22:23], v9 offset:24576
    ds_read_b64_tr_b16 a[26:27], v10 offset:24576
    ds_read_b64_tr_b16 a[30:31], v11 offset:24576
    s_waitcnt lgkmcnt(0)
    s_add_u32 m0, s69, 65536
    s_mov_b32 s66, 327680
    s_nop 0
    buffer_load_dwordx4 v2, s[32:35], s66 offen lds
    buffer_load_dwordx4 v251, s[32:35], s66 offen offset:1024 lds
    s_add_u32 m0, s69, 73728
    s_mov_b32 s66, 348160
    s_nop 0
    buffer_load_dwordx4 v2, s[32:35], s66 offen lds
    buffer_load_dwordx4 v251, s[32:35], s66 offen offset:1024 lds
    s_waitcnt vmcnt(26)
    ds_read_b64_tr_b16 a[32:33], v3 offset:32768
    ds_read_b64_tr_b16 a[36:37], v9 offset:32768
    ds_read_b64_tr_b16 a[40:41], v10 offset:32768
    ds_read_b64_tr_b16 a[44:45], v11 offset:32768
    s_waitcnt vmcnt(24)
    ds_read_b64_tr_b16 a[34:35], v3 offset:40960
    ds_read_b64_tr_b16 a[38:39], v9 offset:40960
    ds_read_b64_tr_b16 a[42:43], v10 offset:40960
    ds_read_b64_tr_b16 a[46:47], v11 offset:40960
    s_waitcnt lgkmcnt(0)
    s_add_u32 m0, s69, 81920
    s_mov_b32 s66, 368640
    s_nop 0
    buffer_load_dwordx4 v2, s[32:35], s66 offen lds
    buffer_load_dwordx4 v251, s[32:35], s66 offen offset:1024 lds
    s_add_u32 m0, s69, 90112
    s_mov_b32 s66, 389120
    s_nop 0
    buffer_load_dwordx4 v2, s[32:35], s66 offen lds
    buffer_load_dwordx4 v251, s[32:35], s66 offen offset:1024 lds
    s_waitcnt vmcnt(26)
    ds_read_b64_tr_b16 a[48:49], v1 offset:0
    ds_read_b64_tr_b16 a[52:53], v4 offset:0
    ds_read_b64_tr_b16 a[56:57], v6 offset:0
    ds_read_b64_tr_b16 a[60:61], v250 offset:0
    s_waitcnt vmcnt(24)
    ds_read_b64_tr_b16 a[50:51], v1 offset:8192
    ds_read_b64_tr_b16 a[54:55], v4 offset:8192
    ds_read_b64_tr_b16 a[58:59], v6 offset:8192
    ds_read_b64_tr_b16 a[62:63], v250 offset:8192
    s_waitcnt lgkmcnt(0)
    s_add_u32 m0, s69, 98304
    s_mov_b32 s66, 409600
    s_nop 0
    buffer_load_dwordx4 v2, s[32:35], s66 offen lds
    buffer_load_dwordx4 v251, s[32:35], s66 offen offset:1024 lds
    s_add_u32 m0, s69, 106496
    s_mov_b32 s66, 430080
    s_nop 0
    buffer_load_dwordx4 v2, s[32:35], s66 offen lds
    buffer_load_dwordx4 v251, s[32:35], s66 offen offset:1024 lds
    s_waitcnt vmcnt(26)
    ds_read_b64_tr_b16 a[64:65], v1 offset:16384
    ds_read_b64_tr_b16 a[68:69], v4 offset:16384
    ds_read_b64_tr_b16 a[72:73], v6 offset:16384
    ds_read_b64_tr_b16 a[76:77], v250 offset:16384
    s_waitcnt vmcnt(24)
    ds_read_b64_tr_b16 a[66:67], v1 offset:24576
    ds_read_b64_tr_b16 a[70:71], v4 offset:24576
    ds_read_b64_tr_b16 a[74:75], v6 offset:24576
    ds_read_b64_tr_b16 a[78:79], v250 offset:24576
    s_waitcnt lgkmcnt(0)
    s_add_u32 m0, s69, 114688
    s_mov_b32 s66, 450560
    s_nop 0
    buffer_load_dwordx4 v2, s[32:35], s66 offen lds
    buffer_load_dwordx4 v251, s[32:35], s66 offen offset:1024 lds
    s_add_u32 m0, s69, 122880
    s_mov_b32 s66, 471040
    s_nop 0
    buffer_load_dwordx4 v2, s[32:35], s66 offen lds
    buffer_load_dwordx4 v251, s[32:35], s66 offen offset:1024 lds
    s_waitcnt vmcnt(26)
    ds_read_b64_tr_b16 a[80:81], v1 offset:32768
    ds_read_b64_tr_b16 a[84:85], v4 offset:32768
    ds_read_b64_tr_b16 a[88:89], v6 offset:32768
    ds_read_b64_tr_b16 a[92:93], v250 offset:32768
    s_waitcnt vmcnt(24)
    ds_read_b64_tr_b16 a[82:83], v1 offset:40960
    ds_read_b64_tr_b16 a[86:87], v4 offset:40960
    ds_read_b64_tr_b16 a[90:91], v6 offset:40960
    ds_read_b64_tr_b16 a[94:95], v250 offset:40960
    s_waitcnt lgkmcnt(0)
    s_add_u32 m0, s69, 131072
    s_mov_b32 s66, 491520
    s_nop 0
    buffer_load_dwordx4 v2, s[32:35], s66 offen lds
    buffer_load_dwordx4 v251, s[32:35], s66 offen offset:1024 lds
    s_add_u32 m0, s69, 139264
    s_mov_b32 s66, 512000
    s_nop 0
    buffer_load_dwordx4 v2, s[32:35], s66 offen lds
    buffer_load_dwordx4 v251, s[32:35], s66 offen offset:1024 lds
    s_waitcnt vmcnt(26)
    ds_read_b64_tr_b16 a[96:97], v1 offset:49152
    ds_read_b64_tr_b16 a[100:101], v4 offset:49152
    ds_read_b64_tr_b16 a[104:105], v6 offset:49152
    ds_read_b64_tr_b16 a[108:109], v250 offset:49152
    s_waitcnt vmcnt(24)
    ds_read_b64_tr_b16 a[98:99], v1 offset:57344
    ds_read_b64_tr_b16 a[102:103], v4 offset:57344
    ds_read_b64_tr_b16 a[106:107], v6 offset:57344
    ds_read_b64_tr_b16 a[110:111], v250 offset:57344
    s_waitcnt lgkmcnt(0)
    s_add_u32 m0, s69, 147456
    s_mov_b32 s66, 532480
    s_nop 0
    buffer_load_dwordx4 v2, s[32:35], s66 offen lds
    buffer_load_dwordx4 v251, s[32:35], s66 offen offset:1024 lds
    s_add_u32 m0, s69, 155648
    s_mov_b32 s66, 552960
    s_nop 0
    buffer_load_dwordx4 v2, s[32:35], s66 offen lds
    buffer_load_dwordx4 v251, s[32:35], s66 offen offset:1024 lds
    s_waitcnt vmcnt(26)
    ds_read_b64_tr_b16 a[112:113], v3 offset:0
    ds_read_b64_tr_b16 a[116:117], v9 offset:0
    ds_read_b64_tr_b16 a[120:121], v10 offset:0
    ds_read_b64_tr_b16 a[124:125], v11 offset:0
    s_waitcnt vmcnt(24)
    ds_read_b64_tr_b16 a[114:115], v3 offset:8192
    ds_read_b64_tr_b16 a[118:119], v9 offset:8192
    ds_read_b64_tr_b16 a[122:123], v10 offset:8192
    ds_read_b64_tr_b16 a[126:127], v11 offset:8192
    s_waitcnt vmcnt(22)
    ds_read_b64_tr_b16 a[128:129], v3 offset:16384
    ds_read_b64_tr_b16 a[132:133], v9 offset:16384
    ds_read_b64_tr_b16 a[136:137], v10 offset:16384
    ds_read_b64_tr_b16 a[140:141], v11 offset:16384
    s_waitcnt vmcnt(20)
    ds_read_b64_tr_b16 a[130:131], v3 offset:24576
    ds_read_b64_tr_b16 a[134:135], v9 offset:24576
    ds_read_b64_tr_b16 a[138:139], v10 offset:24576
    ds_read_b64_tr_b16 a[142:143], v11 offset:24576
    s_waitcnt vmcnt(18)
    ds_read_b64_tr_b16 a[144:145], v3 offset:32768
    ds_read_b64_tr_b16 a[148:149], v9 offset:32768
    ds_read_b64_tr_b16 a[152:153], v10 offset:32768
    ds_read_b64_tr_b16 a[156:157], v11 offset:32768
    s_waitcnt vmcnt(16)
    ds_read_b64_tr_b16 a[146:147], v3 offset:40960
    ds_read_b64_tr_b16 a[150:151], v9 offset:40960
    ds_read_b64_tr_b16 a[154:155], v10 offset:40960
    ds_read_b64_tr_b16 a[158:159], v11 offset:40960
    s_waitcnt vmcnt(14)
    ds_read_b64_tr_b16 a[160:161], v1 offset:0
    ds_read_b64_tr_b16 a[164:165], v4 offset:0
    ds_read_b64_tr_b16 a[168:169], v6 offset:0
    ds_read_b64_tr_b16 a[172:173], v250 offset:0
    s_waitcnt vmcnt(12)
    ds_read_b64_tr_b16 a[162:163], v1 offset:8192
    ds_read_b64_tr_b16 a[166:167], v4 offset:8192
    ds_read_b64_tr_b16 a[170:171], v6 offset:8192
    ds_read_b64_tr_b16 a[174:175], v250 offset:8192
    s_waitcnt vmcnt(10)
    ds_read_b64_tr_b16 a[176:177], v1 offset:16384
    ds_read_b64_tr_b16 a[180:181], v4 offset:16384
    ds_read_b64_tr_b16 a[184:185], v6 offset:16384
    ds_read_b64_tr_b16 a[188:189], v250 offset:16384
    s_waitcnt vmcnt(8)
    ds_read_b64_tr_b16 a[178:179], v1 offset:24576
    ds_read_b64_tr_b16 a[182:183], v4 offset:24576
    ds_read_b64_tr_b16 a[186:187], v6 offset:24576
    ds_read_b64_tr_b16 a[190:191], v250 offset:24576
    s_waitcnt vmcnt(6)
    ds_read_b64_tr_b16 a[192:193], v1 offset:32768
    ds_read_b64_tr_b16 a[196:197], v4 offset:32768
    ds_read_b64_tr_b16 a[200:201], v6 offset:32768
    ds_read_b64_tr_b16 a[204:205], v250 offset:32768
    s_waitcnt vmcnt(4)
    ds_read_b64_tr_b16 a[194:195], v1 offset:40960
    ds_read_b64_tr_b16 a[198:199], v4 offset:40960
    ds_read_b64_tr_b16 a[202:203], v6 offset:40960
    ds_read_b64_tr_b16 a[206:207], v250 offset:40960
    s_waitcnt vmcnt(2)
    ds_read_b64_tr_b16 a[208:209], v1 offset:49152
    ds_read_b64_tr_b16 a[212:213], v4 offset:49152
    ds_read_b64_tr_b16 a[216:217], v6 offset:49152
    ds_read_b64_tr_b16 a[220:221], v250 offset:49152
    s_waitcnt vmcnt(0)
    ds_read_b64_tr_b16 a[210:211], v1 offset:57344
    ds_read_b64_tr_b16 a[214:215], v4 offset:57344
    ds_read_b64_tr_b16 a[218:219], v6 offset:57344
    ds_read_b64_tr_b16 a[222:223], v250 offset:57344
L_slow2:
    s_mov_b32 s68, 0
L_slow2_l:
    buffer_load_dword v14, off, s[40:43], 0 sc1
    s_waitcnt vmcnt(0)
    v_cmp_eq_u32 vcc, 1, v14
    s_bcnt1_i32_b64 s58, vcc
    s_cmp_eq_u32 s58, 64
    s_cbranch_scc1 L_back2
    s_add_u32 s68, s68, 1
    s_cmp_gt_u32 s68, 200000
    s_cbranch_scc1 L_back2
    s_sleep 16
    s_branch L_slow2_l
L_back2:
    s_branch L_ith1
L_itbh1:
    s_cmp_lg_u32 s48, 0
    s_cbranch_scc1 L_gone
    s_lshl_b32 s66, s62, 3
    s_add_u32 s66, s66, s63
    s_lshl_b32 s66, s66, 7
    s_add_u32 s66, s66, 32768
    v_lshlrev_b32 v2, 20, v0
L_waitgo:
    s_mov_b32 s68, 0
L_waitgo_l:
    buffer_load_dword v14, v2, s[44:47], s66 offen sc1
    s_waitcnt vmcnt(0)
    v_cmp_eq_u32 vcc, 1, v14
    s_bcnt1_i32_b64 s58, vcc
    s_cmp_eq_u32 s58, 1
    s_cbranch_scc1 L_gone
    s_add_u32 s68, s68, 1
    s_cmp_gt_u32 s68, 200000
    s_cbranch_scc1 L_gone
    s_sleep 4
    s_branch L_waitgo_l
L_gone:
    s_barrier
    s_waitcnt lgkmcnt(0)
    buffer_load_dword v14, v5, s[44:47], s4 offen sc1
    v_accvgpr_read_b32 v208, a224
    v_accvgpr_read_b32 v209, a225
    v_accvgpr_read_b32 v210, a226
    v_accvgpr_read_b32 v211, a227
    v_accvgpr_read_b32 v212, a228
    s_waitcnt vmcnt(0)
    v_cmp_eq_u32 vcc, 1, v14
    s_cmp_lg_u64 vcc, s[10:11]
    s_cbranch_scc1 L_waith0
L_goh0:
    s_add_u32 s67, s83, 0
    buffer_load_dwordx4 v[144:147], v211, s[28:31], s67 offen offset:0 sc1
    buffer_load_dwordx4 v[148:151], v211, s[28:31], s67 offen offset:1024 sc1
    buffer_load_dwordx4 v[152:155], v211, s[28:31], s67 offen offset:2048 sc1
    buffer_load_dwordx4 v[156:159], v211, s[28:31], s67 offen offset:3072 sc1
    buffer_load_dword v14, v5, s[44:47], s5 offen sc1
    s_add_u32 s67, s83, 4096
    buffer_load_dwordx4 v[160:163], v211, s[28:31], s67 offen offset:0 sc1
    buffer_load_dwordx4 v[164:167], v211, s[28:31], s67 offen offset:1024 sc1
    buffer_load_dwordx4 v[168:171], v211, s[28:31], s67 offen offset:2048 sc1
    buffer_load_dwordx4 v[172:175], v211, s[28:31], s67 offen offset:3072 sc1
L_rowh0:
    s_waitcnt vmcnt(7)
    v_mfma_f32_16x16x32_bf16 v[16:19], a[0:3], v[144:147], 0
    s_add_u32 s67, s83, 8192
    v_mfma_f32_16x16x32_bf16 v[16:19], a[16:19], v[148:151], v[16:19]
    buffer_load_dwordx4 v[176:179], v211, s[28:31], s67 offen offset:0 sc1
    v_mfma_f32_16x16x32_bf16 v[20:23], a[4:7], v[144:147], 0
    v_mfma_f32_16x16x32_bf16 v[20:23], a[20:23], v[148:151], v[20:23]
    buffer_load_dwordx4 v[180:183], v211, s[28:31], s67 offen offset:1024 sc1
    v_mfma_f32_16x16x32_bf16 v[24:27], a[8:11], v[144:147], 0
    v_mfma_f32_16x16x32_bf16 v[24:27], a[24:27], v[148:151], v[24:27]
    buffer_load_dwordx4 v[184:187], v211, s[28:31], s67 offen offset:2048 sc1
    v_mfma_f32_16x16x32_bf16 v[28:31], a[12:15], v[144:147], 0
    v_mfma_f32_16x16x32_bf16 v[28:31], a[28:31], v[148:151], v[28:31]
    buffer_load_dwordx4 v[188:191], v211, s[28:31], s67 offen offset:3072 sc1
    s_waitcnt vmcnt(9)
    v_mfma_f32_16x16x32_bf16 v[16:19], a[32:35], v[152:155], v[16:19]
    s_add_u32 s67, s83, 12288
    v_mfma_f32_16x16x32_bf16 v[16:19], a[48:51], v[156:159], v[16:19]
    buffer_load_dwordx4 v[192:195], v212, s[28:31], s67 offen offset:0 sc1
    v_mfma_f32_16x16x32_bf16 v[20:23], a[36:39], v[152:155], v[20:23]
    v_mfma_f32_16x16x32_bf16 v[20:23], a[52:55], v[156:159], v[20:23]
    buffer_load_dwordx4 v[196:199], v212, s[28:31], s67 offen offset:1024 sc1
    v_mfma_f32_16x16x32_bf16 v[24:27], a[40:43], v[152:155], v[24:27]
    s_waitcnt vmcnt(10)
    v_cmp_eq_u32 vcc, 1, v14
    v_mfma_f32_16x16x32_bf16 v[24:27], a[56:59], v[156:159], v[24:27]
    s_cmp_lg_u64 vcc, s[10:11]
    s_cbranch_scc1 L_waith1
L_goh1:
    s_add_u32 s67, s84, 0
    buffer_load_dwordx4 v[200:203], v211, s[28:31], s67 offen offset:0 sc1
    v_mfma_f32_16x16x32_bf16 v[28:31], a[44:47], v[152:155], v[28:31]
    v_mfma_f32_16x16x32_bf16 v[28:31], a[60:63], v[156:159], v[28:31]
    buffer_load_dwordx4 v[204:207], v211, s[28:31], s67 offen offset:1024 sc1
    s_waitcnt vmcnt(10)
    v_mfma_f32_16x16x32_bf16 v[16:19], a[64:67], v[160:163], v[16:19]
    v_mfma_f32_16x16x32_bf16 v[16:19], a[80:83], v[164:167], v[16:19]
    buffer_load_dwordx4 v[144:147], v211, s[28:31], s67 offen offset:2048 sc1
    v_mfma_f32_16x16x32_bf16 v[20:23], a[68:71], v[160:163], v[20:23]
    v_mfma_f32_16x16x32_bf16 v[20:23], a[84:87], v[164:167], v[20:23]
    buffer_load_dwordx4 v[148:151], v211, s[28:31], s67 offen offset:3072 sc1
    v_mfma_f32_16x16x32_bf16 v[24:27], a[72:75], v[160:163], v[24:27]
    s_add_u32 s67, s84, 4096
    v_mfma_f32_16x16x32_bf16 v[24:27], a[88:91], v[164:167], v[24:27]
    buffer_load_dwordx4 v[152:155], v211, s[28:31], s67 offen offset:0 sc1
    v_mfma_f32_16x16x32_bf16 v[28:31], a[76:79], v[160:163], v[28:31]
    v_mfma_f32_16x16x32_bf16 v[28:31], a[92:95], v[164:167], v[28:31]
    buffer_load_dword v14, v5, s[44:47], s6 offen sc1
    s_waitcnt vmcnt(12)
    v_mfma_f32_16x16x32_bf16 v[16:19], a[96:99], v[168:171], v[16:19]
    v_mfma_f32_16x16x32_bf16 v[16:19], a[112:115], v[172:175], v[16:19]
    buffer_load_dwordx4 v[156:159], v211, s[28:31], s67 offen offset:1024 sc1
    v_mfma_f32_16x16x32_bf16 v[20:23], a[100:103], v[168:171], v[20:23]
    v_mfma_f32_16x16x32_bf16 v[20:23], a[116:119], v[172:175], v[20:23]
    buffer_load_dwordx4 v[160:163], v211, s[28:31], s67 offen offset:2048 sc1
    v_mfma_f32_16x16x32_bf16 v[24:27], a[104:107], v[168:171], v[24:27]
    v_mfma_f32_16x16x32_bf16 v[24:27], a[120:123], v[172:175], v[24:27]
    buffer_load_dwordx4 v[164:167], v211, s[28:31], s67 offen offset:3072 sc1
    v_mfma_f32_16x16x32_bf16 v[28:31], a[108:111], v[168:171], v[28:31]
    s_add_u32 s67, s84, 8192
    v_mfma_f32_16x16x32_bf16 v[28:31], a[124:127], v[172:175], v[28:31]
    s_waitcnt vmcnt(13)
    v_mfma_f32_16x16x32_bf16 v[16:19], a[128:131], v[176:179], v[16:19]
    v_mfma_f32_16x16x32_bf16 v[16:19], a[144:147], v[180:183], v[16:19]
    buffer_load_dwordx4 v[168:171], v211, s[28:31], s67 offen offset:0 sc1
    v_mfma_f32_16x16x32_bf16 v[20:23], a[132:135], v[176:179], v[20:23]
    v_mfma_f32_16x16x32_bf16 v[20:23], a[148:151], v[180:183], v[20:23]
    v_mfma_f32_16x16x32_bf16 v[24:27], a[136:139], v[176:179], v[24:27]
    v_mfma_f32_16x16x32_bf16 v[24:27], a[152:155], v[180:183], v[24:27]
    buffer_load_dwordx4 v[172:175], v211, s[28:31], s67 offen offset:1024 sc1
    v_mfma_f32_16x16x32_bf16 v[28:31], a[140:143], v[176:179], v[28:31]
    v_mfma_f32_16x16x32_bf16 v[28:31], a[156:159], v[180:183], v[28:31]
    s_waitcnt vmcnt(13)
    v_mfma_f32_16x16x32_bf16 v[16:19], a[160:163], v[184:187], v[16:19]
    v_mfma_f32_16x16x32_bf16 v[16:19], a[176:179], v[188:191], v[16:19]
    buffer_load_dwordx4 v[176:179], v211, s[28:31], s67 offen offset:2048 sc1
    v_mfma_f32_16x16x32_bf16 v[20:23], a[164:167], v[184:187], v[20:23]
    v_mfma_f32_16x16x32_bf16 v[20:23], a[180:183], v[188:191], v[20:23]
    v_mfma_f32_16x16x32_bf16 v[24:27], a[168:171], v[184:187], v[24:27]
    v_mfma_f32_16x16x32_bf16 v[24:27], a[184:187], v[188:191], v[24:27]
    buffer_load_dwordx4 v[180:183], v211, s[28:31], s67 offen offset:3072 sc1
    v_mfma_f32_16x16x32_bf16 v[28:31], a[172:175], v[184:187], v[28:31]
    s_add_u32 s67, s84, 12288
    v_mfma_f32_16x16x32_bf16 v[28:31], a[188:191], v[188:191], v[28:31]
    s_waitcnt vmcnt(13)
    v_mfma_f32_16x16x32_bf16 v[16:19], a[192:195], v[192:195], v[16:19]
    v_mfma_f32_16x16x32_bf16 v[16:19], a[208:211], v[196:199], v[16:19]
    buffer_load_dwordx4 v[184:187], v212, s[28:31], s67 offen offset:0 sc1
    v_mfma_f32_16x16x32_bf16 v[20:23], a[196:199], v[192:195], v[20:23]
    v_mfma_f32_16x16x32_bf16 v[20:23], a[212:215], v[196:199], v[20:23]
    v_mfma_f32_16x16x32_bf16 v[24:27], a[200:203], v[192:195], v[24:27]
    v_mfma_f32_16x16x32_bf16 v[24:27], a[216:219], v[196:199], v[24:27]
    buffer_load_dwordx4 v[188:191], v212, s[28:31], s67 offen offset:1024 sc1
    v_mfma_f32_16x16x32_bf16 v[28:31], a[204:207], v[192:195], v[28:31]
    s_waitcnt vmcnt(9)
    v_cmp_eq_u32 vcc, 1, v14
    v_mfma_f32_16x16x32_bf16 v[28:31], a[220:223], v[196:199], v[28:31]
    s_cmp_lg_u64 vcc, s[10:11]
    s_cbranch_scc1 L_waith2
L_goh2:
L_rowh1:
    s_branch L_pgh1
    .p2align 12
L_ith1:
    s_branch L_itbh1
L_pgh1:
    s_waitcnt vmcnt(13)
    v_mfma_f32_16x16x32_bf16 v[32:35], a[0:3], v[200:203], 0
    s_add_u32 s67, s85, 0
    v_mfma_f32_16x16x32_bf16 v[32:35], a[16:19], v[204:207], v[32:35]
    buffer_load_dwordx4 v[192:195], v211, s[28:31], s67 offen offset:0 sc1
    v_mfma_f32_16x16x32_bf16 v[36:39], a[4:7], v[200:203], 0
    v_mfma_f32_16x16x32_bf16 v[36:39], a[20:23], v[204:207], v[36:39]
    v_mfma_f32_16x16x32_bf16 v[40:43], a[8:11], v[200:203], 0
    v_mfma_f32_16x16x32_bf16 v[40:43], a[24:27], v[204:207], v[40:43]
    buffer_load_dwordx4 v[196:199], v211, s[28:31], s67 offen offset:1024 sc1
    v_mfma_f32_16x16x32_bf16 v[44:47], a[12:15], v[200:203], 0
    v_mfma_f32_16x16x32_bf16 v[44:47], a[28:31], v[204:207], v[44:47]
    s_barrier
    s_waitcnt vmcnt(13)
    v_mfma_f32_16x16x32_bf16 v[32:35], a[32:35], v[144:147], v[32:35]
    v_mfma_f32_16x16x32_bf16 v[32:35], a[48:51], v[148:151], v[32:35]
    buffer_load_dwordx4 v[200:203], v211, s[28:31], s67 offen offset:2048 sc1
    v_mfma_f32_16x16x32_bf16 v[36:39], a[36:39], v[144:147], v[36:39]
    ds_write_b128 v210, v[16:19] offset:0
    v_mfma_f32_16x16x32_bf16 v[36:39], a[52:55], v[148:151], v[36:39]
    v_mfma_f32_16x16x32_bf16 v[40:43], a[40:43], v[144:147], v[40:43]
    v_mfma_f32_16x16x32_bf16 v[40:43], a[56:59], v[148:151], v[40:43]
    buffer_load_dwordx4 v[204:207], v211, s[28:31], s67 offen offset:3072 sc1
    v_mfma_f32_16x16x32_bf16 v[44:47], a[44:47], v[144:147], v[44:47]
    ds_write_b128 v210, v[20:23] offset:1056
    v_mfma_f32_16x16x32_bf16 v[44:47], a[60:63], v[148:151], v[44:47]
    buffer_load_dword v14, v5, s[44:47], s7 offen sc1
    s_waitcnt vmcnt(13)
    v_mfma_f32_16x16x32_bf16 v[32:35], a[64:67], v[152:155], v[32:35]
    s_add_u32 s67, s85, 4096
    v_mfma_f32_16x16x32_bf16 v[32:35], a[80:83], v[156:159], v[32:35]
    buffer_load_dwordx4 v[144:147], v211, s[28:31], s67 offen offset:0 sc1
    v_mfma_f32_16x16x32_bf16 v[36:39], a[68:71], v[152:155], v[36:39]
    ds_write_b128 v210, v[24:27] offset:2112
    v_mfma_f32_16x16x32_bf16 v[36:39], a[84:87], v[156:159], v[36:39]
    v_mfma_f32_16x16x32_bf16 v[40:43], a[72:75], v[152:155], v[40:43]
    v_mfma_f32_16x16x32_bf16 v[40:43], a[88:91], v[156:159], v[40:43]
    buffer_load_dwordx4 v[148:151], v211, s[28:31], s67 offen offset:1024 sc1
    v_mfma_f32_16x16x32_bf16 v[44:47], a[76:79], v[152:155], v[44:47]
    ds_write_b128 v210, v[28:31] offset:3168
    v_mfma_f32_16x16x32_bf16 v[44:47], a[92:95], v[156:159], v[44:47]
    s_waitcnt vmcnt(13)
    v_mfma_f32_16x16x32_bf16 v[32:35], a[96:99], v[160:163], v[32:35]
    v_mfma_f32_16x16x32_bf16 v[32:35], a[112:115], v[164:167], v[32:35]
    buffer_load_dwordx4 v[152:155], v211, s[28:31], s67 offen offset:2048 sc1
    v_mfma_f32_16x16x32_bf16 v[36:39], a[100:103], v[160:163], v[36:39]
    v_mfma_f32_16x16x32_bf16 v[36:39], a[116:119], v[164:167], v[36:39]
    v_mfma_f32_16x16x32_bf16 v[40:43], a[104:107], v[160:163], v[40:43]
    v_mfma_f32_16x16x32_bf16 v[40:43], a[120:123], v[164:167], v[40:43]
    buffer_load_dwordx4 v[156:159], v211, s[28:31], s67 offen offset:3072 sc1
    v_mfma_f32_16x16x32_bf16 v[44:47], a[108:111], v[160:163], v[44:47]
    s_add_u32 s67, s85, 8192
    v_mfma_f32_16x16x32_bf16 v[44:47], a[124:127], v[164:167], v[44:47]
    s_waitcnt vmcnt(13)
    v_mfma_f32_16x16x32_bf16 v[32:35], a[128:131], v[168:171], v[32:35]
    v_mfma_f32_16x16x32_bf16 v[32:35], a[144:147], v[172:175], v[32:35]
    buffer_load_dwordx4 v[160:163], v211, s[28:31], s67 offen offset:0 sc1
    v_mfma_f32_16x16x32_bf16 v[36:39], a[132:135], v[168:171], v[36:39]
    v_mfma_f32_16x16x32_bf16 v[36:39], a[148:151], v[172:175], v[36:39]
    v_mfma_f32_16x16x32_bf16 v[40:43], a[136:139], v[168:171], v[40:43]
    v_mfma_f32_16x16x32_bf16 v[40:43], a[152:155], v[172:175], v[40:43]
    buffer_load_dwordx4 v[164:167], v211, s[28:31], s67 offen offset:1024 sc1
    v_mfma_f32_16x16x32_bf16 v[44:47], a[140:143], v[168:171], v[44:47]
    v_mfma_f32_16x16x32_bf16 v[44:47], a[156:159], v[172:175], v[44:47]
    s_waitcnt vmcnt(13)
    v_mfma_f32_16x16x32_bf16 v[32:35], a[160:163], v[176:179], v[32:35]
    v_mfma_f32_16x16x32_bf16 v[32:35], a[176:179], v[180:183], v[32:35]
    buffer_load_dwordx4 v[168:171], v211, s[28:31], s67 offen offset:2048 sc1
    v_mfma_f32_16x16x32_bf16 v[36:39], a[164:167], v[176:179], v[36:39]
    v_mfma_f32_16x16x32_bf16 v[36:39], a[180:183], v[180:183], v[36:39]
    v_mfma_f32_16x16x32_bf16 v[40:43], a[168:171], v[176:179], v[40:43]
    v_mfma_f32_16x16x32_bf16 v[40:43], a[184:187], v[180:183], v[40:43]
    buffer_load_dwordx4 v[172:175], v211, s[28:31], s67 offen offset:3072 sc1
    v_mfma_f32_16x16x32_bf16 v[44:47], a[172:175], v[176:179], v[44:47]
    s_add_u32 s67, s85, 12288
    v_mfma_f32_16x16x32_bf16 v[44:47], a[188:191], v[180:183], v[44:47]
    s_waitcnt vmcnt(13)
    v_mfma_f32_16x16x32_bf16 v[32:35], a[192:195], v[184:187], v[32:35]
    v_mfma_f32_16x16x32_bf16 v[32:35], a[208:211], v[188:191], v[32:35]
    buffer_load_dwordx4 v[176:179], v212, s[28:31], s67 offen offset:0 sc1
    v_mfma_f32_16x16x32_bf16 v[36:39], a[196:199], v[184:187], v[36:39]
    v_mfma_f32_16x16x32_bf16 v[36:39], a[212:215], v[188:191], v[36:39]
    v_mfma_f32_16x16x32_bf16 v[40:43], a[200:203], v[184:187], v[40:43]
    v_mfma_f32_16x16x32_bf16 v[40:43], a[216:219], v[188:191], v[40:43]
    buffer_load_dwordx4 v[180:183], v212, s[28:31], s67 offen offset:1024 sc1
    v_mfma_f32_16x16x32_bf16 v[44:47], a[204:207], v[184:187], v[44:47]
    s_waitcnt vmcnt(10)
    v_cmp_eq_u32 vcc, 1, v14
    v_mfma_f32_16x16x32_bf16 v[44:47], a[220:223], v[188:191], v[44:47]
    s_cmp_lg_u64 vcc, s[10:11]
    s_cbranch_scc1 L_waith3
L_goh3:
L_rowh2:
    s_waitcnt vmcnt(13)
    v_mfma_f32_16x16x32_bf16 v[96:99], a[0:3], v[192:195], 0
    s_add_u32 s67, s86, 0
    v_mfma_f32_16x16x32_bf16 v[96:99], a[16:19], v[196:199], v[96:99]
    buffer_load_dwordx4 v[184:187], v211, s[28:31], s67 offen offset:0 sc1
    v_mfma_f32_16x16x32_bf16 v[100:103], a[4:7], v[192:195], 0
    v_mfma_f32_16x16x32_bf16 v[100:103], a[20:23], v[196:199], v[100:103]
    v_mfma_f32_16x16x32_bf16 v[104:107], a[8:11], v[192:195], 0
    v_mfma_f32_16x16x32_bf16 v[104:107], a[24:27], v[196:199], v[104:107]
    buffer_load_dwordx4 v[188:191], v211, s[28:31], s67 offen offset:1024 sc1
    v_mfma_f32_16x16x32_bf16 v[108:111], a[12:15], v[192:195], 0
    v_mfma_f32_16x16x32_bf16 v[108:111], a[28:31], v[196:199], v[108:111]
    s_waitcnt vmcnt(13)
    v_mfma_f32_16x16x32_bf16 v[96:99], a[32:35], v[200:203], v[96:99]
    v_mfma_f32_16x16x32_bf16 v[96:99], a[48:51], v[204:207], v[96:99]
    buffer_load_dwordx4 v[192:195], v211, s[28:31], s67 offen offset:2048 sc1
    v_mfma_f32_16x16x32_bf16 v[100:103], a[36:39], v[200:203], v[100:103]
    ds_write_b128 v210, v[32:35] offset:16896
    v_mfma_f32_16x16x32_bf16 v[100:103], a[52:55], v[204:207], v[100:103]
    v_mfma_f32_16x16x32_bf16 v[104:107], a[40:43], v[200:203], v[104:107]
    v_mfma_f32_16x16x32_bf16 v[104:107], a[56:59], v[204:207], v[104:107]
    buffer_load_dwordx4 v[196:199], v211, s[28:31], s67 offen offset:3072 sc1
    v_mfma_f32_16x16x32_bf16 v[108:111], a[44:47], v[200:203], v[108:111]
    ds_write_b128 v210, v[36:39] offset:17952
    v_mfma_f32_16x16x32_bf16 v[108:111], a[60:63], v[204:207], v[108:111]
    buffer_load_dword v14, v5, s[44:47], s8 offen sc1
    s_waitcnt vmcnt(13)
    v_mfma_f32_16x16x32_bf16 v[96:99], a[64:67], v[144:147], v[96:99]
    s_add_u32 s67, s86, 4096
    v_mfma_f32_16x16x32_bf16 v[96:99], a[80:83], v[148:151], v[96:99]
    buffer_load_dwordx4 v[200:203], v211, s[28:31], s67 offen offset:0 sc1
    v_mfma_f32_16x16x32_bf16 v[100:103], a[68:71], v[144:147], v[100:103]
    ds_write_b128 v210, v[40:43] offset:19008
    v_mfma_f32_16x16x32_bf16 v[100:103], a[84:87], v[148:151], v[100:103]
    v_mfma_f32_16x16x32_bf16 v[104:107], a[72:75], v[144:147], v[104:107]
    v_mfma_f32_16x16x32_bf16 v[104:107], a[88:91], v[148:151], v[104:107]
    buffer_load_dwordx4 v[204:207], v211, s[28:31], s67 offen offset:1024 sc1
    v_mfma_f32_16x16x32_bf16 v[108:111], a[76:79], v[144:147], v[108:111]
    ds_write_b128 v210, v[44:47] offset:20064
    v_mfma_f32_16x16x32_bf16 v[108:111], a[92:95], v[148:151], v[108:111]
    s_waitcnt vmcnt(13)
    v_mfma_f32_16x16x32_bf16 v[96:99], a[96:99], v[152:155], v[96:99]
    v_mfma_f32_16x16x32_bf16 v[96:99], a[112:115], v[156:159], v[96:99]
    buffer_load_dwordx4 v[144:147], v211, s[28:31], s67 offen offset:2048 sc1
    v_mfma_f32_16x16x32_bf16 v[100:103], a[100:103], v[152:155], v[100:103]
    v_mfma_f32_16x16x32_bf16 v[100:103], a[116:119], v[156:159], v[100:103]
    s_waitcnt lgkmcnt(0)
    s_barrier
    v_mfma_f32_16x16x32_bf16 v[104:107], a[104:107], v[152:155], v[104:107]
    ds_read_b128 v[56:59], v209 offset:0
    v_mfma_f32_16x16x32_bf16 v[104:107], a[120:123], v[156:159], v[104:107]
    buffer_load_dwordx4 v[148:151], v211, s[28:31], s67 offen offset:3072 sc1
    v_mfma_f32_16x16x32_bf16 v[108:111], a[108:111], v[152:155], v[108:111]
    s_add_u32 s67, s86, 8192
    v_mfma_f32_16x16x32_bf16 v[108:111], a[124:127], v[156:159], v[108:111]
    ds_read_b128 v[60:63], v209 offset:256
    s_waitcnt vmcnt(13)
    v_mfma_f32_16x16x32_bf16 v[96:99], a[128:131], v[160:163], v[96:99]
    ds_read_b128 v[64:67], v209 offset:4224
    v_mfma_f32_16x16x32_bf16 v[96:99], a[144:147], v[164:167], v[96:99]
    buffer_load_dwordx4 v[152:155], v211, s[28:31], s67 offen offset:0 sc1
    v_mfma_f32_16x16x32_bf16 v[100:103], a[132:135], v[160:163], v[100:103]
    ds_read_b128 v[68:71], v209 offset:4480
    v_mfma_f32_16x16x32_bf16 v[100:103], a[148:151], v[164:167], v[100:103]
    ds_read_b128 v[72:75], v209 offset:8448
    v_mfma_f32_16x16x32_bf16 v[104:107], a[136:139], v[160:163], v[104:107]
    ds_read_b128 v[76:79], v209 offset:8704
    v_mfma_f32_16x16x32_bf16 v[104:107], a[152:155], v[164:167], v[104:107]
    buffer_load_dwordx4 v[156:159], v211, s[28:31], s67 offen offset:1024 sc1
    v_mfma_f32_16x16x32_bf16 v[108:111], a[140:143], v[160:163], v[108:111]
    ds_read_b128 v[80:83], v209 offset:12672
    v_mfma_f32_16x16x32_bf16 v[108:111], a[156:159], v[164:167], v[108:111]
    ds_read_b128 v[84:87], v209 offset:12928
    s_waitcnt vmcnt(13)
    v_mfma_f32_16x16x32_bf16 v[96:99], a[160:163], v[168:171], v[96:99]
    v_mfma_f32_16x16x32_bf16 v[96:99], a[176:179], v[172:175], v[96:99]
    buffer_load_dwordx4 v[160:163], v211, s[28:31], s67 offen offset:2048 sc1
    v_mfma_f32_16x16x32_bf16 v[100:103], a[164:167], v[168:171], v[100:103]
    v_mfma_f32_16x16x32_bf16 v[100:103], a[180:183], v[172:175], v[100:103]
    s_waitcnt lgkmcnt(4)
    v_add_f32 v56, v56, v64
    v_add_f32 v57, v57, v65
    v_mfma_f32_16x16x32_bf16 v[104:107], a[168:171], v[168:171], v[104:107]
    v_add_f32 v58, v58, v66
    v_add_f32 v59, v59, v67
    v_mfma_f32_16x16x32_bf16 v[104:107], a[184:187], v[172:175], v[104:107]
    buffer_load_dwordx4 v[164:167], v211, s[28:31], s67 offen offset:3072 sc1
    v_mfma_f32_16x16x32_bf16 v[108:111], a[172:175], v[168:171], v[108:111]
    s_add_u32 s67, s86, 12288
    v_mfma_f32_16x16x32_bf16 v[108:111], a[188:191], v[172:175], v[108:111]
    v_add_f32 v60, v60, v68
    v_add_f32 v61, v61, v69
    s_waitcnt vmcnt(13)
    v_mfma_f32_16x16x32_bf16 v[96:99], a[192:195], v[176:179], v[96:99]
    v_add_f32 v62, v62, v70
    v_add_f32 v63, v63, v71
    v_mfma_f32_16x16x32_bf16 v[96:99], a[208:211], v[180:183], v[96:99]
    buffer_load_dwordx4 v[168:171], v212, s[28:31], s67 offen offset:0 sc1
    v_mfma_f32_16x16x32_bf16 v[100:103], a[196:199], v[176:179], v[100:103]
    s_waitcnt lgkmcnt(2)
    v_add_f32 v56, v56, v72
    v_add_f32 v57, v57, v73
    v_mfma_f32_16x16x32_bf16 v[100:103], a[212:215], v[180:183], v[100:103]
    v_add_f32 v58, v58, v74
    v_add_f32 v59, v59, v75
    v_mfma_f32_16x16x32_bf16 v[104:107], a[200:203], v[176:179], v[104:107]
    v_add_f32 v60, v60, v76
    v_add_f32 v61, v61, v77
    v_mfma_f32_16x16x32_bf16 v[104:107], a[216:219], v[180:183], v[104:107]
    buffer_load_dwordx4 v[172:175], v212, s[28:31], s67 offen offset:1024 sc1
    v_mfma_f32_16x16x32_bf16 v[108:111], a[204:207], v[176:179], v[108:111]
    s_waitcnt vmcnt(10)
    v_cmp_eq_u32 vcc, 1, v14
    v_mfma_f32_16x16x32_bf16 v[108:111], a[220:223], v[180:183], v[108:111]
    s_cmp_lg_u64 vcc, s[10:11]
    s_cbranch_scc1 L_waith4
L_goh4:
L_rowh3:
    s_waitcnt vmcnt(13)
    v_mfma_f32_16x16x32_bf16 v[16:19], a[0:3], v[184:187], 0
    s_add_u32 s67, s87, 0
    v_mfma_f32_16x16x32_bf16 v[16:19], a[16:19], v[188:191], v[16:19]
    buffer_load_dwordx4 v[176:179], v211, s[28:31], s67 offen offset:0 sc1
    v_mfma_f32_16x16x32_bf16 v[20:23], a[4:7], v[184:187], 0
    v_add_f32 v62, v62, v78
    v_add_f32 v63, v63, v79
    v_mfma_f32_16x16x32_bf16 v[20:23], a[20:23], v[188:191], v[20:23]
    s_waitcnt lgkmcnt(0)
    v_add_f32 v56, v56, v80
    v_add_f32 v57, v57, v81
    v_mfma_f32_16x16x32_bf16 v[24:27], a[8:11], v[184:187], 0
    v_add_f32 v58, v58, v82
    v_add_f32 v59, v59, v83
    v_mfma_f32_16x16x32_bf16 v[24:27], a[24:27], v[188:191], v[24:27]
    buffer_load_dwordx4 v[180:183], v211, s[28:31], s67 offen offset:1024 sc1
    v_mfma_f32_16x16x32_bf16 v[28:31], a[12:15], v[184:187], 0
    v_add_f32 v60, v60, v84
    v_add_f32 v61, v61, v85
    v_mfma_f32_16x16x32_bf16 v[28:31], a[28:31], v[188:191], v[28:31]
    v_add_f32 v62, v62, v86
    v_add_f32 v63, v63, v87
    s_waitcnt vmcnt(13)
    v_mfma_f32_16x16x32_bf16 v[16:19], a[32:35], v[192:195], v[16:19]
    v_cvt_pk_bf16_f32 v88, v56, v57
    v_cvt_pk_bf16_f32 v89, v58, v59
    v_mfma_f32_16x16x32_bf16 v[16:19], a[48:51], v[196:199], v[16:19]
    buffer_load_dwordx4 v[184:187], v211, s[28:31], s67 offen offset:2048 sc1
    v_mfma_f32_16x16x32_bf16 v[20:23], a[36:39], v[192:195], v[20:23]
    ds_write_b128 v210, v[96:99] offset:33792
    v_mfma_f32_16x16x32_bf16 v[20:23], a[52:55], v[196:199], v[20:23]
    v_cvt_pk_bf16_f32 v90, v60, v61
    v_cvt_pk_bf16_f32 v91, v62, v63
    v_mfma_f32_16x16x32_bf16 v[24:27], a[40:43], v[192:195], v[24:27]
    buffer_store_dwordx4 v[88:91], v208, s[36:39], s76 offen
    v_mfma_f32_16x16x32_bf16 v[24:27], a[56:59], v[196:199], v[24:27]
    buffer_load_dwordx4 v[188:191], v211, s[28:31], s67 offen offset:3072 sc1
    v_mfma_f32_16x16x32_bf16 v[28:31], a[44:47], v[192:195], v[28:31]
    ds_write_b128 v210, v[100:103] offset:34848
    v_mfma_f32_16x16x32_bf16 v[28:31], a[60:63], v[196:199], v[28:31]
    buffer_load_dword v14, v5, s[44:47], s9 offen sc1
    s_waitcnt vmcnt(14)
    v_mfma_f32_16x16x32_bf16 v[16:19], a[64:67], v[200:203], v[16:19]
    s_add_u32 s67, s87, 4096
    v_mfma_f32_16x16x32_bf16 v[16:19], a[80:83], v[204:207], v[16:19]
    buffer_load_dwordx4 v[192:195], v211, s[28:31], s67 offen offset:0 sc1
    v_mfma_f32_16x16x32_bf16 v[20:23], a[68:71], v[200:203], v[20:23]
    ds_write_b128 v210, v[104:107] offset:35904
    v_mfma_f32_16x16x32_bf16 v[20:23], a[84:87], v[204:207], v[20:23]
    v_mfma_f32_16x16x32_bf16 v[24:27], a[72:75], v[200:203], v[24:27]
    v_mfma_f32_16x16x32_bf16 v[24:27], a[88:91], v[204:207], v[24:27]
    buffer_load_dwordx4 v[196:199], v211, s[28:31], s67 offen offset:1024 sc1
    v_mfma_f32_16x16x32_bf16 v[28:31], a[76:79], v[200:203], v[28:31]
    ds_write_b128 v210, v[108:111] offset:36960
    v_mfma_f32_16x16x32_bf16 v[28:31], a[92:95], v[204:207], v[28:31]
    s_waitcnt vmcnt(14)
    v_mfma_f32_16x16x32_bf16 v[16:19], a[96:99], v[144:147], v[16:19]
    v_mfma_f32_16x16x32_bf16 v[16:19], a[112:115], v[148:151], v[16:19]
    buffer_load_dwordx4 v[200:203], v211, s[28:31], s67 offen offset:2048 sc1
    v_mfma_f32_16x16x32_bf16 v[20:23], a[100:103], v[144:147], v[20:23]
    v_mfma_f32_16x16x32_bf16 v[20:23], a[116:119], v[148:151], v[20:23]
    v_mfma_f32_16x16x32_bf16 v[24:27], a[104:107], v[144:147], v[24:27]
    v_mfma_f32_16x16x32_bf16 v[24:27], a[120:123], v[148:151], v[24:27]
    buffer_load_dwordx4 v[204:207], v211, s[28:31], s67 offen offset:3072 sc1
    v_mfma_f32_16x16x32_bf16 v[28:31], a[108:111], v[144:147], v[28:31]
    s_add_u32 s67, s87, 8192
    v_mfma_f32_16x16x32_bf16 v[28:31], a[124:127], v[148:151], v[28:31]
    s_waitcnt vmcnt(14)
    v_mfma_f32_16x16x32_bf16 v[16:19], a[128:131], v[152:155], v[16:19]
    v_mfma_f32_16x16x32_bf16 v[16:19], a[144:147], v[156:159], v[16:19]
    buffer_load_dwordx4 v[144:147], v211, s[28:31], s67 offen offset:0 sc1
    v_mfma_f32_16x16x32_bf16 v[20:23], a[132:135], v[152:155], v[20:23]
    v_mfma_f32_16x16x32_bf16 v[20:23], a[148:151], v[156:159], v[20:23]
    v_mfma_f32_16x16x32_bf16 v[24:27], a[136:139], v[152:155], v[24:27]
    v_mfma_f32_16x16x32_bf16 v[24:27], a[152:155], v[156:159], v[24:27]
    buffer_load_dwordx4 v[148:151], v211, s[28:31], s67 offen offset:1024 sc1
    v_mfma_f32_16x16x32_bf16 v[28:31], a[140:143], v[152:155], v[28:31]
    v_mfma_f32_16x16x32_bf16 v[28:31], a[156:159], v[156:159], v[28:31]
    s_waitcnt vmcnt(14)
    v_mfma_f32_16x16x32_bf16 v[16:19], a[160:163], v[160:163], v[16:19]
    v_mfma_f32_16x16x32_bf16 v[16:19], a[176:179], v[164:167], v[16:19]
    buffer_load_dwordx4 v[152:155], v211, s[28:31], s67 offen offset:2048 sc1
    v_mfma_f32_16x16x32_bf16 v[20:23], a[164:167], v[160:163], v[20:23]
    v_mfma_f32_16x16x32_bf16 v[20:23], a[180:183], v[164:167], v[20:23]
    v_mfma_f32_16x16x32_bf16 v[24:27], a[168:171], v[160:163], v[24:27]
    v_mfma_f32_16x16x32_bf16 v[24:27], a[184:187], v[164:167], v[24:27]
    buffer_load_dwordx4 v[156:159], v211, s[28:31], s67 offen offset:3072 sc1
    v_mfma_f32_16x16x32_bf16 v[28:31], a[172:175], v[160:163], v[28:31]
    s_add_u32 s67, s87, 12288
    v_mfma_f32_16x16x32_bf16 v[28:31], a[188:191], v[164:167], v[28:31]
    s_waitcnt vmcnt(14)
    v_mfma_f32_16x16x32_bf16 v[16:19], a[192:195], v[168:171], v[16:19]
    v_mfma_f32_16x16x32_bf16 v[16:19], a[208:211], v[172:175], v[16:19]
    buffer_load_dwordx4 v[160:163], v212, s[28:31], s67 offen offset:0 sc1
    v_mfma_f32_16x16x32_bf16 v[20:23], a[196:199], v[168:171], v[20:23]
    v_mfma_f32_16x16x32_bf16 v[20:23], a[212:215], v[172:175], v[20:23]
    v_mfma_f32_16x16x32_bf16 v[24:27], a[200:203], v[168:171], v[24:27]
    v_mfma_f32_16x16x32_bf16 v[24:27], a[216:219], v[172:175], v[24:27]
    v_mfma_f32_16x16x32_bf16 v[28:31], a[204:207], v[168:171], v[28:31]
    v_mfma_f32_16x16x32_bf16 v[28:31], a[220:223], v[172:175], v[28:31]
L_rowh4:
    s_waitcnt vmcnt(13)
    v_mfma_f32_16x16x32_bf16 v[32:35], a[0:3], v[176:179], 0
    v_mfma_f32_16x16x32_bf16 v[32:35], a[16:19], v[180:183], v[32:35]
    buffer_load_dwordx4 v[164:167], v212, s[28:31], s67 offen offset:1024 sc1
    v_mfma_f32_16x16x32_bf16 v[36:39], a[4:7], v[176:179], 0
    s_waitcnt vmcnt(10)
    v_cmp_eq_u32 vcc, 1, v14
    v_mfma_f32_16x16x32_bf16 v[36:39], a[20:23], v[180:183], v[36:39]
    s_cmp_lg_u64 vcc, s[10:11]
    s_cbranch_scc1 L_waith5
L_goh5:
    v_mfma_f32_16x16x32_bf16 v[40:43], a[8:11], v[176:179], 0
    s_add_u32 s67, s88, 0
    v_mfma_f32_16x16x32_bf16 v[40:43], a[24:27], v[180:183], v[40:43]
    buffer_load_dwordx4 v[168:171], v211, s[28:31], s67 offen offset:0 sc1
    v_mfma_f32_16x16x32_bf16 v[44:47], a[12:15], v[176:179], 0
    v_mfma_f32_16x16x32_bf16 v[44:47], a[28:31], v[180:183], v[44:47]
    s_waitcnt vmcnt(12)
    v_mfma_f32_16x16x32_bf16 v[32:35], a[32:35], v[184:187], v[32:35]
    v_mfma_f32_16x16x32_bf16 v[32:35], a[48:51], v[188:191], v[32:35]
    buffer_load_dwordx4 v[172:175], v211, s[28:31], s67 offen offset:1024 sc1
    v_mfma_f32_16x16x32_bf16 v[36:39], a[36:39], v[184:187], v[36:39]
    ds_write_b128 v210, v[16:19] offset:50688
    v_mfma_f32_16x16x32_bf16 v[36:39], a[52:55], v[188:191], v[36:39]
    v_mfma_f32_16x16x32_bf16 v[40:43], a[40:43], v[184:187], v[40:43]
    v_mfma_f32_16x16x32_bf16 v[40:43], a[56:59], v[188:191], v[40:43]
    v_mfma_f32_16x16x32_bf16 v[44:47], a[44:47], v[184:187], v[44:47]
    ds_write_b128 v210, v[20:23] offset:51744
    v_mfma_f32_16x16x32_bf16 v[44:47], a[60:63], v[188:191], v[44:47]
    s_waitcnt vmcnt(10)
    v_mfma_f32_16x16x32_bf16 v[32:35], a[64:67], v[192:195], v[32:35]
    v_mfma_f32_16x16x32_bf16 v[32:35], a[80:83], v[196:199], v[32:35]
    buffer_load_dwordx4 v[176:179], v211, s[28:31], s67 offen offset:2048 sc1
    v_mfma_f32_16x16x32_bf16 v[36:39], a[68:71], v[192:195], v[36:39]
    ds_write_b128 v210, v[24:27] offset:52800
    v_mfma_f32_16x16x32_bf16 v[36:39], a[84:87], v[196:199], v[36:39]
    v_mfma_f32_16x16x32_bf16 v[40:43], a[72:75], v[192:195], v[40:43]
    v_mfma_f32_16x16x32_bf16 v[40:43], a[88:91], v[196:199], v[40:43]
    buffer_load_dwordx4 v[180:183], v211, s[28:31], s67 offen offset:3072 sc1
    v_mfma_f32_16x16x32_bf16 v[44:47], a[76:79], v[192:195], v[44:47]
    ds_write_b128 v210, v[28:31] offset:53856
    v_mfma_f32_16x16x32_bf16 v[44:47], a[92:95], v[196:199], v[44:47]
    s_add_u32 s67, s88, 4096
    s_waitcnt vmcnt(10)
    v_mfma_f32_16x16x32_bf16 v[32:35], a[96:99], v[200:203], v[32:35]
    v_mfma_f32_16x16x32_bf16 v[32:35], a[112:115], v[204:207], v[32:35]
    buffer_load_dwordx4 v[184:187], v211, s[28:31], s67 offen offset:0 sc1
    v_mfma_f32_16x16x32_bf16 v[36:39], a[100:103], v[200:203], v[36:39]
    v_mfma_f32_16x16x32_bf16 v[36:39], a[116:119], v[204:207], v[36:39]
    s_waitcnt lgkmcnt(0)
    s_barrier
    v_mfma_f32_16x16x32_bf16 v[40:43], a[104:107], v[200:203], v[40:43]
    ds_read_b128 v[56:59], v209 offset:33792
    v_mfma_f32_16x16x32_bf16 v[40:43], a[120:123], v[204:207], v[40:43]
    ds_read_b128 v[60:63], v209 offset:34048
    v_mfma_f32_16x16x32_bf16 v[44:47], a[108:111], v[200:203], v[44:47]
    ds_read_b128 v[64:67], v209 offset:38016
    v_mfma_f32_16x16x32_bf16 v[44:47], a[124:127], v[204:207], v[44:47]
    ds_read_b128 v[68:71], v209 offset:38272
    s_waitcnt vmcnt(9)
    v_mfma_f32_16x16x32_bf16 v[32:35], a[128:131], v[144:147], v[32:35]
    ds_read_b128 v[72:75], v209 offset:42240
    v_mfma_f32_16x16x32_bf16 v[32:35], a[144:147], v[148:151], v[32:35]
    buffer_load_dwordx4 v[188:191], v211, s[28:31], s67 offen offset:1024 sc1
    v_mfma_f32_16x16x32_bf16 v[36:39], a[132:135], v[144:147], v[36:39]
    ds_read_b128 v[76:79], v209 offset:42496
    v_mfma_f32_16x16x32_bf16 v[36:39], a[148:151], v[148:151], v[36:39]
    ds_read_b128 v[80:83], v209 offset:46464
    v_mfma_f32_16x16x32_bf16 v[40:43], a[136:139], v[144:147], v[40:43]
    ds_read_b128 v[84:87], v209 offset:46720
    v_mfma_f32_16x16x32_bf16 v[40:43], a[152:155], v[148:151], v[40:43]
    buffer_load_dwordx4 v[192:195], v211, s[28:31], s67 offen offset:2048 sc1
    v_mfma_f32_16x16x32_bf16 v[44:47], a[140:143], v[144:147], v[44:47]
    v_mfma_f32_16x16x32_bf16 v[44:47], a[156:159], v[148:151], v[44:47]
    s_waitcnt vmcnt(9)
    v_mfma_f32_16x16x32_bf16 v[32:35], a[160:163], v[152:155], v[32:35]
    s_waitcnt lgkmcnt(4)
    v_add_f32 v56, v56, v64
    v_add_f32 v57, v57, v65
    v_mfma_f32_16x16x32_bf16 v[32:35], a[176:179], v[156:159], v[32:35]
    buffer_load_dwordx4 v[196:199], v211, s[28:31], s67 offen offset:3072 sc1
    v_mfma_f32_16x16x32_bf16 v[36:39], a[164:167], v[152:155], v[36:39]
    v_add_f32 v58, v58, v66
    v_add_f32 v59, v59, v67
    v_mfma_f32_16x16x32_bf16 v[36:39], a[180:183], v[156:159], v[36:39]
    v_add_f32 v60, v60, v68
    v_add_f32 v61, v61, v69
    v_mfma_f32_16x16x32_bf16 v[40:43], a[168:171], v[152:155], v[40:43]
    s_add_u32 s67, s88, 8192
    v_mfma_f32_16x16x32_bf16 v[40:43], a[184:187], v[156:159], v[40:43]
    v_add_f32 v62, v62, v70
    v_add_f32 v63, v63, v71
    v_mfma_f32_16x16x32_bf16 v[44:47], a[172:175], v[152:155], v[44:47]
    s_waitcnt lgkmcnt(2)
    v_add_f32 v56, v56, v72
    v_add_f32 v57, v57, v73
    v_mfma_f32_16x16x32_bf16 v[44:47], a[188:191], v[156:159], v[44:47]
    v_add_f32 v58, v58, v74
    v_add_f32 v59, v59, v75
    s_waitcnt vmcnt(8)
    v_mfma_f32_16x16x32_bf16 v[32:35], a[192:195], v[160:163], v[32:35]
    v_add_f32 v60, v60, v76
    v_add_f32 v61, v61, v77
    v_mfma_f32_16x16x32_bf16 v[32:35], a[208:211], v[164:167], v[32:35]
    buffer_load_dwordx4 v[200:203], v211, s[28:31], s67 offen offset:0 sc1
    v_mfma_f32_16x16x32_bf16 v[36:39], a[196:199], v[160:163], v[36:39]
    v_add_f32 v62, v62, v78
    v_add_f32 v63, v63, v79
    v_mfma_f32_16x16x32_bf16 v[36:39], a[212:215], v[164:167], v[36:39]
    s_waitcnt lgkmcnt(0)
    v_add_f32 v56, v56, v80
    v_add_f32 v57, v57, v81
    v_mfma_f32_16x16x32_bf16 v[40:43], a[200:203], v[160:163], v[40:43]
    v_add_f32 v58, v58, v82
    v_add_f32 v59, v59, v83
    v_mfma_f32_16x16x32_bf16 v[40:43], a[216:219], v[164:167], v[40:43]
    buffer_load_dwordx4 v[204:207], v211, s[28:31], s67 offen offset:1024 sc1
    v_mfma_f32_16x16x32_bf16 v[44:47], a[204:207], v[160:163], v[44:47]
    v_add_f32 v60, v60, v84
    v_add_f32 v61, v61, v85
    v_mfma_f32_16x16x32_bf16 v[44:47], a[220:223], v[164:167], v[44:47]
    v_add_f32 v62, v62, v86
    v_add_f32 v63, v63, v87
L_rowh5:
    s_waitcnt vmcnt(8)
    v_mfma_f32_16x16x32_bf16 v[96:99], a[0:3], v[168:171], 0
    v_cvt_pk_bf16_f32 v88, v56, v57
    v_cvt_pk_bf16_f32 v89, v58, v59
    v_mfma_f32_16x16x32_bf16 v[96:99], a[16:19], v[172:175], v[96:99]
    buffer_load_dwordx4 v[144:147], v211, s[28:31], s67 offen offset:2048 sc1
    v_mfma_f32_16x16x32_bf16 v[100:103], a[4:7], v[168:171], 0
    v_cvt_pk_bf16_f32 v90, v60, v61
    v_cvt_pk_bf16_f32 v91, v62, v63
    v_mfma_f32_16x16x32_bf16 v[100:103], a[20:23], v[172:175], v[100:103]
    buffer_store_dwordx4 v[88:91], v208, s[36:39], s77 offen
    v_mfma_f32_16x16x32_bf16 v[104:107], a[8:11], v[168:171], 0
    v_mfma_f32_16x16x32_bf16 v[104:107], a[24:27], v[172:175], v[104:107]
    v_mfma_f32_16x16x32_bf16 v[108:111], a[12:15], v[168:171], 0
    v_mfma_f32_16x16x32_bf16 v[108:111], a[28:31], v[172:175], v[108:111]
    s_waitcnt vmcnt(8)
    v_mfma_f32_16x16x32_bf16 v[96:99], a[32:35], v[176:179], v[96:99]
    v_mfma_f32_16x16x32_bf16 v[96:99], a[48:51], v[180:183], v[96:99]
    buffer_load_dwordx4 v[148:151], v211, s[28:31], s67 offen offset:3072 sc1
    v_mfma_f32_16x16x32_bf16 v[100:103], a[36:39], v[176:179], v[100:103]
    ds_write_b128 v210, v[32:35] offset:0
    v_mfma_f32_16x16x32_bf16 v[100:103], a[52:55], v[180:183], v[100:103]
    s_add_u32 s67, s88, 12288
    v_mfma_f32_16x16x32_bf16 v[104:107], a[40:43], v[176:179], v[104:107]
    v_mfma_f32_16x16x32_bf16 v[104:107], a[56:59], v[180:183], v[104:107]
    buffer_load_dwordx4 v[152:155], v212, s[28:31], s67 offen offset:0 sc1
    v_mfma_f32_16x16x32_bf16 v[108:111], a[44:47], v[176:179], v[108:111]
    ds_write_b128 v210, v[36:39] offset:1056
    v_mfma_f32_16x16x32_bf16 v[108:111], a[60:63], v[180:183], v[108:111]
    s_waitcnt vmcnt(8)
    v_mfma_f32_16x16x32_bf16 v[96:99], a[64:67], v[184:187], v[96:99]
    v_mfma_f32_16x16x32_bf16 v[96:99], a[80:83], v[188:191], v[96:99]
    buffer_load_dwordx4 v[156:159], v212, s[28:31], s67 offen offset:1024 sc1
    v_mfma_f32_16x16x32_bf16 v[100:103], a[68:71], v[184:187], v[100:103]
    ds_write_b128 v210, v[40:43] offset:2112
    v_mfma_f32_16x16x32_bf16 v[100:103], a[84:87], v[188:191], v[100:103]
    v_mfma_f32_16x16x32_bf16 v[104:107], a[72:75], v[184:187], v[104:107]
    v_mfma_f32_16x16x32_bf16 v[104:107], a[88:91], v[188:191], v[104:107]
    v_mfma_f32_16x16x32_bf16 v[108:111], a[76:79], v[184:187], v[108:111]
    ds_write_b128 v210, v[44:47] offset:3168
    v_mfma_f32_16x16x32_bf16 v[108:111], a[92:95], v[188:191], v[108:111]
    s_waitcnt vmcnt(7)
    v_mfma_f32_16x16x32_bf16 v[96:99], a[96:99], v[192:195], v[96:99]
    v_mfma_f32_16x16x32_bf16 v[96:99], a[112:115], v[196:199], v[96:99]
    v_mfma_f32_16x16x32_bf16 v[100:103], a[100:103], v[192:195], v[100:103]
    v_mfma_f32_16x16x32_bf16 v[100:103], a[116:119], v[196:199], v[100:103]
    v_mfma_f32_16x16x32_bf16 v[104:107], a[104:107], v[192:195], v[104:107]
    v_mfma_f32_16x16x32_bf16 v[104:107], a[120:123], v[196:199], v[104:107]
    v_mfma_f32_16x16x32_bf16 v[108:111], a[108:111], v[192:195], v[108:111]
    v_mfma_f32_16x16x32_bf16 v[108:111], a[124:127], v[196:199], v[108:111]
    s_waitcnt vmcnt(5)
    v_mfma_f32_16x16x32_bf16 v[96:99], a[128:131], v[200:203], v[96:99]
    v_mfma_f32_16x16x32_bf16 v[96:99], a[144:147], v[204:207], v[96:99]
    v_mfma_f32_16x16x32_bf16 v[100:103], a[132:135], v[200:203], v[100:103]
    v_mfma_f32_16x16x32_bf16 v[100:103], a[148:151], v[204:207], v[100:103]
    v_mfma_f32_16x16x32_bf16 v[104:107], a[136:139], v[200:203], v[104:107]
    v_mfma_f32_16x16x32_bf16 v[104:107], a[152:155], v[204:207], v[104:107]
    v_mfma_f32_16x16x32_bf16 v[108:111], a[140:143], v[200:203], v[108:111]
    v_mfma_f32_16x16x32_bf16 v[108:111], a[156:159], v[204:207], v[108:111]
    s_waitcnt vmcnt(0)
    v_mfma_f32_16x16x32_bf16 v[96:99], a[160:163], v[144:147], v[96:99]
    v_mfma_f32_16x16x32_bf16 v[96:99], a[176:179], v[148:151], v[96:99]
    v_mfma_f32_16x16x32_bf16 v[96:99], a[192:195], v[152:155], v[96:99]
    v_mfma_f32_16x16x32_bf16 v[96:99], a[208:211], v[156:159], v[96:99]
    v_mfma_f32_16x16x32_bf16 v[100:103], a[164:167], v[144:147], v[100:103]
    v_mfma_f32_16x16x32_bf16 v[100:103], a[180:183], v[148:151], v[100:103]
    v_mfma_f32_16x16x32_bf16 v[100:103], a[196:199], v[152:155], v[100:103]
    v_mfma_f32_16x16x32_bf16 v[100:103], a[212:215], v[156:159], v[100:103]
    v_mfma_f32_16x16x32_bf16 v[104:107], a[168:171], v[144:147], v[104:107]
    v_mfma_f32_16x16x32_bf16 v[104:107], a[184:187], v[148:151], v[104:107]
    v_mfma_f32_16x16x32_bf16 v[104:107], a[200:203], v[152:155], v[104:107]
    v_mfma_f32_16x16x32_bf16 v[104:107], a[216:219], v[156:159], v[104:107]
    ds_write_b128 v210, v[96:99] offset:16896
    v_mfma_f32_16x16x32_bf16 v[108:111], a[172:175], v[144:147], v[108:111]
    v_mfma_f32_16x16x32_bf16 v[108:111], a[188:191], v[148:151], v[108:111]
    v_mfma_f32_16x16x32_bf16 v[108:111], a[204:207], v[152:155], v[108:111]
    v_mfma_f32_16x16x32_bf16 v[108:111], a[220:223], v[156:159], v[108:111]
    ds_write_b128 v210, v[100:103] offset:17952
    s_nop 2
    ds_write_b128 v210, v[104:107] offset:19008
    s_nop 3
    ds_write_b128 v210, v[108:111] offset:20064
    s_waitcnt lgkmcnt(0)
    s_barrier
    ds_read_b128 v[56:59], v209 offset:0
    ds_read_b128 v[60:63], v209 offset:256
    ds_read_b128 v[64:67], v209 offset:4224
    ds_read_b128 v[68:71], v209 offset:4480
    ds_read_b128 v[72:75], v209 offset:8448
    ds_read_b128 v[76:79], v209 offset:8704
    ds_read_b128 v[80:83], v209 offset:12672
    ds_read_b128 v[84:87], v209 offset:12928
    s_waitcnt lgkmcnt(4)
    v_pk_add_f32 v[56:57], v[56:57], v[64:65]
    v_pk_add_f32 v[58:59], v[58:59], v[66:67]
    v_pk_add_f32 v[60:61], v[60:61], v[68:69]
    v_pk_add_f32 v[62:63], v[62:63], v[70:71]
    s_waitcnt lgkmcnt(2)
    v_pk_add_f32 v[56:57], v[56:57], v[72:73]
    v_pk_add_f32 v[58:59], v[58:59], v[74:75]
    v_pk_add_f32 v[60:61], v[60:61], v[76:77]
    v_pk_add_f32 v[62:63], v[62:63], v[78:79]
    s_waitcnt lgkmcnt(0)
    v_pk_add_f32 v[56:57], v[56:57], v[80:81]
    v_pk_add_f32 v[58:59], v[58:59], v[82:83]
    v_pk_add_f32 v[60:61], v[60:61], v[84:85]
    v_pk_add_f32 v[62:63], v[62:63], v[86:87]
    v_cvt_pk_bf16_f32 v88, v56, v57
    v_cvt_pk_bf16_f32 v89, v58, v59
    v_cvt_pk_bf16_f32 v90, v60, v61
    v_cvt_pk_bf16_f32 v91, v62, v63
    buffer_store_dwordx4 v[88:91], v208, s[36:39], s78 offen
    s_branch L_fin
L_waith0:
    s_mov_b32 s68, 0
L_waith0_l:
    buffer_load_dword v14, v5, s[44:47], s4 offen sc1
    s_waitcnt vmcnt(0)
    v_cmp_eq_u32 vcc, 1, v14
    s_bcnt1_i32_b64 s58, vcc
    s_cmp_eq_u32 s58, s72
    s_cbranch_scc1 L_goh0
    s_add_u32 s68, s68, 1
    s_cmp_gt_u32 s68, 200000
    s_cbranch_scc1 L_goh0
    s_sleep 2
    s_branch L_waith0_l
L_waith1:
    s_mov_b32 s68, 0
L_waith1_l:
    buffer_load_dword v14, v5, s[44:47], s5 offen sc1
    s_waitcnt vmcnt(0)
    v_cmp_eq_u32 vcc, 1, v14
    s_bcnt1_i32_b64 s58, vcc
    s_cmp_eq_u32 s58, s72
    s_cbranch_scc1 L_goh1
    s_add_u32 s68, s68, 1
    s_cmp_gt_u32 s68, 200000
    s_cbranch_scc1 L_goh1
    s_sleep 2
    s_branch L_waith1_l
L_waith2:
    s_mov_b32 s68, 0
L_waith2_l:
    buffer_load_dword v14, v5, s[44:47], s6 offen sc1
    s_waitcnt vmcnt(0)
    v_cmp_eq_u32 vcc, 1, v14
    s_bcnt1_i32_b64 s58, vcc
    s_cmp_eq_u32 s58, s72
    s_cbranch_scc1 L_goh2
    s_add_u32 s68, s68, 1
    s_cmp_gt_u32 s68, 200000
    s_cbranch_scc1 L_goh2
    s_sleep 2
    s_branch L_waith2_l
L_waith3:
    s_mov_b32 s68, 0
L_waith3_l:
    buffer_load_dword v14, v5, s[44:47], s7 offen sc1
    s_waitcnt vmcnt(0)
    v_cmp_eq_u32 vcc, 1, v14
    s_bcnt1_i32_b64 s58, vcc
    s_cmp_eq_u32 s58, s72
    s_cbranch_scc1 L_goh3
    s_add_u32 s68, s68, 1
    s_cmp_gt_u32 s68, 200000
    s_cbranch_scc1 L_goh3
    s_sleep 2
    s_branch L_waith3_l
L_waith4:
    s_mov_b32 s68, 0
L_waith4_l:
    buffer_load_dword v14, v5, s[44:47], s8 offen sc1
    s_waitcnt vmcnt(0)
    v_cmp_eq_u32 vcc, 1, v14
    s_bcnt1_i32_b64 s58, vcc
    s_cmp_eq_u32 s58, s72
    s_cbranch_scc1 L_goh4
    s_add_u32 s68, s68, 1
    s_cmp_gt_u32 s68, 200000
    s_cbranch_scc1 L_goh4
    s_sleep 2
    s_branch L_waith4_l
L_waith5:
    s_mov_b32 s68, 0
L_waith5_l:
    buffer_load_dword v14, v5, s[44:47], s9 offen sc1
    s_waitcnt vmcnt(0)
    v_cmp_eq_u32 vcc, 1, v14
    s_bcnt1_i32_b64 s58, vcc
    s_cmp_eq_u32 s58, s72
    s_cbranch_scc1 L_goh5
    s_add_u32 s68, s68, 1
    s_cmp_gt_u32 s68, 200000
    s_cbranch_scc1 L_goh5
    s_sleep 2
    s_branch L_waith5_l
L_codeend:
.section .rodata,"a"
.p2align 6
.amdhsa_kernel standalone__glu_gated_geglu__prompt_kernel
  .amdhsa_next_free_vgpr 512
  .amdhsa_next_free_sgpr 96
  .amdhsa_accum_offset 256
  .amdhsa_group_segment_fixed_size 0
  .amdhsa_kernarg_size 56
  .amdhsa_user_sgpr_count 2
  .amdhsa_user_sgpr_kernarg_segment_ptr 1
  .amdhsa_system_sgpr_workgroup_id_x 1
.end_amdhsa_kernel
```
